```python
import torch

def _softmax(x, axis=-1):
    return torch.softmax(x, dim=axis)
def _gelu(x):
    return torch.nn.functional.gelu(x, approximate="tanh")
def _silu(x):
    return torch.nn.functional.silu(x)
def _sigmoid(x):
    return torch.sigmoid(x)
def _layernorm(x, axis=-1, eps=1e-5):
    m = x.mean(dim=axis, keepdim=True)
    v = x.var(dim=axis, keepdim=True, unbiased=False)
    return (x - m) / torch.sqrt(v + eps)
def _scatter_add(tgt, idx, src, axis=0):
    return tgt.clone().index_add_(axis, idx, src)
def _segment_sum(src, seg, n):
    out = torch.zeros((n,) + src.shape[1:], dtype=src.dtype)
    return out.index_add_(0, seg, src)
def _pad(x, pw):
    flat = tuple(v for pair in reversed(pw) for v in pair)
    return torch.nn.functional.pad(x, flat)

kernel_name = 'parallel_sum__linear_attn_block__glu_gated_reglu__prompt'

def setup_inputs():

    _w = (lambda a: (lambda t: t.to(torch.bfloat16) if t.is_floating_point() else t)(torch.as_tensor(a)))
    def _A_setup():
        B, S, D = 1, 2048, 448
        return {
            "x": _w((lambda *s: torch.randn(*s, dtype=torch.bfloat16) * 0.05)(B, S, D)),
            "wqkv": _w((lambda *s: torch.randn(*s, dtype=torch.bfloat16) * 0.1)(D, 3 * D)),
            "wo": _w((lambda *s: torch.randn(*s, dtype=torch.bfloat16) * 0.05)(D, D)),
        }
    _A_in = _A_setup()

    def _B_setup():
        B, S, D, F = 1, 2048, 448, 1792
        return {
            "x": _w((lambda *s: torch.randn(*s, dtype=torch.bfloat16) * 0.05)(B, S, D)),
            "W_gate": _w((lambda *s: torch.randn(*s, dtype=torch.bfloat16) * 0.2)(D, F) * (2.0 / D) ** 0.5),
            "W_up": _w((lambda *s: torch.randn(*s, dtype=torch.bfloat16) * 0.2)(D, F) * (2.0 / D) ** 0.5),
            "W_down": _w((lambda *s: torch.randn(*s, dtype=torch.bfloat16) * 0.2)(F, D) * (1.0 / F) ** 0.5),
        }
    _B_in = _B_setup()

    return {
        "A_x": _A_in["x"],
        "A_wqkv": _A_in["wqkv"],
        "A_wo": _A_in["wo"],
        "B_x": _B_in["x"],
        "B_W_gate": _B_in["W_gate"],
        "B_W_up": _B_in["W_up"],
        "B_W_down": _B_in["W_down"],
    }

def reference(A_x, A_wqkv, A_wo, B_x, B_W_gate, B_W_up, B_W_down):
    def _A_ref(x, wqkv, wo):
        B, S, D = x.shape
        H = 16; Dh = D // H
        qkv = (lambda x, *d: x.permute(*d))((x @ wqkv).reshape(B, S, 3, H, Dh), 2, 0, 3, 1, 4)
        q, k, v = qkv[0], qkv[1], qkv[2]
        phi = lambda t: torch.where(t > 0, t + 1, torch.exp(t)) + 1e-6
        pq, pk = phi(q), phi(k)
        kv = torch.einsum("bhsd,bhse->bhde", pk, v)
        z = torch.einsum("bhsd->bhd", pk)
        num = torch.einsum("bhqd,bhde->bhqe", pq, kv)
        den = torch.einsum("bhqd,bhd->bhq", pq, z)[..., None] + 1e-6
        o = num / den
        return (lambda x, *d: x.permute(*d))(o, 0, 2, 1, 3).reshape(B, S, D) @ wo

    def _B_ref(x, W_gate, W_up, W_down):
        gate = torch.einsum("bsd,df->bsf", x, W_gate)
        up = torch.einsum("bsd,df->bsf", x, W_up)
        gate = gate * (lambda x, dt: x.to(dt))(gate > 0, gate.dtype)
        h = gate * up
        return torch.einsum("bsf,fd->bsd", h, W_down)

    x = A_x
    xn = _layernorm(x, axis=-1)
    return x + _A_ref(xn, A_wqkv, A_wo) + _B_ref(xn, B_W_gate, B_W_up, B_W_down)
```

```asm
; @launch grid=(256,1,1) block=(256,1,1) lds=162304
.amdgcn_target "amdgcn-amd-amdhsa--gfx950"
.text
.globl parallel_sum__linear_attn_block__glu_gated_reglu__prompt_kernel
.p2align 8
.type parallel_sum__linear_attn_block__glu_gated_reglu__prompt_kernel,@function
parallel_sum__linear_attn_block__glu_gated_reglu__prompt_kernel:
    s_cmp_ge_u32 s2, 256
    s_cbranch_scc1 L_exit
    s_load_dwordx4 s[4:7], s[0:1], 0
    s_load_dwordx4 s[8:11], s[0:1], 32
    s_load_dwordx2 s[12:13], s[0:1], 72
    s_load_dwordx4 s[76:79], s[0:1], 48
    s_load_dwordx2 s[98:99], s[0:1], 16
    v_and_b32 v1, 63, v0
    s_cmp_ge_u32 s2, 128
    s_cbranch_scc1 L_nocpf
    s_getpc_b64 s[90:91]
L_pc:
    s_bfe_u32 s92, s2, 0x30003
    s_lshl_b32 s92, s92, 12
    v_lshrrev_b32 v2, 6, v0
    v_and_b32 v3, 7, v0
    v_lshl_add_u32 v2, v2, 3, v3
    v_lshl_add_u32 v2, v2, 7, s92
    v_min_u32 v2, L_exit-L_pc, v2
    global_load_dword v254, v2, s[90:91]
L_nocpf:
    v_lshrrev_b32 v2, 6, v0
    s_and_b32 s48, s2, 1
    s_lshl_b32 s48, s48, 3
    s_bfe_u32 s49, s2, 0x30003
    s_add_u32 s36, s48, s49
    v_readfirstlane_b32 s38, v2
    v_lshrrev_b32 v6, 3, v1
    v_lshrrev_b32 v7, 4, v1
    s_bfe_u32 s48, s2, 0x20001
    v_mul_u32_u24 v6, 896, v6
    v_xor_b32 v7, v7, v1
    s_lshl_b32 s48, s48, 2
    v_and_b32 v7, 7, v7
    s_bfe_u32 s50, s2, 0x20006
    v_lshl_add_u32 v16, v7, 4, v6
    s_add_u32 s37, s48, s50
    v_xor_b32 v7, 64, v16
    s_lshl_b32 s44, s36, 2
    v_add_u32 v18, 12288, v16
    s_add_u32 s44, s44, s38
    v_add_u32 v17, 6144, v7
    s_mul_i32 s44, s44, 28672
    v_add_u32 v19, 18432, v7
    s_lshl_b32 s40, s38, 12
    v_bfe_u32 v2, v1, 2, 3
    s_lshr_b32 s48, s38, 1
    v_mul_u32_u24 v2, 3584, v2
    s_and_b32 s49, s38, 1
    v_lshrrev_b32 v3, 5, v1
    s_mul_i32 s39, s48, 8224
    v_lshl_add_u32 v2, v3, 6, v2
    s_lshl_b32 s51, s49, 12
    v_and_b32 v3, 3, v1
    s_add_u32 s39, s39, s51
    v_lshl_add_u32 v8, v3, 4, v2
    s_add_u32 s39, s39, 16384
    v_add_u32 v9, 27648, v8
    v_add_u32 v10, 55296, v8
    v_add_u32 v11, 82944, v8
    s_mul_i32 s42, s49, 114688
    s_mul_i32 s51, s37, 224
    s_add_u32 s42, s42, s51
    s_lshl_b32 s51, s50, 5
    s_add_u32 s42, s42, s51
    s_lshl_b32 s67, s2, 2
    s_add_u32 s67, s67, s38
    s_bfe_u32 s48, s2, 0x30003
    s_mul_i32 s3, s48, 1
    s_sub_u32 s48, s3, 7
    s_cmp_ge_u32 s3, 7
    s_cselect_b32 s3, s48, s3
    s_mov_b32 s58, s3
    s_mov_b32 s59, s3
    s_lshl_b32 s48, s3, 7
    s_add_u32 s44, s44, s48
    s_mul_i32 s48, s3, 229376
    s_add_u32 s42, s42, s48
    s_waitcnt lgkmcnt(0)
    s_mov_b32 s24, s4
    s_mov_b32 s25, s5
    s_and_b32 s25, s25, 0xffff
    s_mov_b32 s26, 0x1c0000
    s_mov_b32 s27, 0x20000
    s_add_u32 m0, s40, 0
    s_nop 0
    buffer_load_dwordx4 v16, s[24:27], s44 offen offset:0 lds
    buffer_load_dwordx4 v17, s[24:27], s44 offen offset:1024 lds
    s_cmp_ge_u32 s38, 2
    s_cselect_b32 s16, s10, s8
    s_cselect_b32 s17, s11, s9
    s_and_b32 s17, s17, 0xffff
    s_mov_b32 s18, 1605632
    s_mov_b32 s19, 0x20000
    s_add_u32 m0, s39, 0
    s_nop 0
    buffer_load_dwordx4 v8, s[16:19], s42 offen offset:0 lds
    buffer_load_dwordx4 v9, s[16:19], s42 offen offset:1024 lds
    s_add_u32 m0, s40, 0
    s_nop 0
    buffer_load_dwordx4 v18, s[24:27], s44 offen offset:2048 lds
    buffer_load_dwordx4 v19, s[24:27], s44 offen offset:3072 lds
    s_add_u32 s44, s44, 128
    s_cmp_eq_u32 s58, 6
    s_cselect_b32 s48, 896, 0
    s_sub_u32 s44, s44, s48
    s_add_u32 m0, s39, 0
    s_nop 0
    buffer_load_dwordx4 v10, s[16:19], s42 offen offset:2048 lds
    buffer_load_dwordx4 v11, s[16:19], s42 offen offset:3072 lds
    s_add_u32 s42, s42, 229376
    s_cmp_eq_u32 s58, 6
    s_cselect_b32 s48, 1605632, 0
    s_sub_u32 s42, s42, s48
    s_add_u32 s58, s58, 1
    s_lshl_b32 s66, s36, 6
    s_lshl_b32 s48, s37, 2
    v_lshlrev_b32 v15, 4, v1
    s_add_u32 s66, s66, s48
    v_mov_b32 v2, 0x40000000
    v_cmp_gt_u32 vcc, 56, v1
    s_add_u32 s66, s66, s38
    s_nop 0
    v_cndmask_b32 v169, v2, v15, vcc
    s_mul_i32 s48, s67, 2731
    s_lshr_b32 s48, s48, 16
    s_mul_i32 s49, s48, 24
    s_sub_u32 s49, s67, s49
    s_lshr_b32 s50, s49, 3
    s_and_b32 s49, s49, 7
    s_mul_i32 s46, s49, 56
    s_add_u32 s46, s46, s48
    s_mul_i32 s46, s46, 3
    s_add_u32 s46, s46, s50
    s_lshl_b32 s46, s46, 10
    s_mul_i32 s64, s48, 43008
    s_mul_i32 s49, s49, 112
    s_add_u32 s64, s64, s49
    s_add_u32 s50, s50, 1
    s_cmp_eq_u32 s50, 3
    s_cselect_b32 s50, 0, s50
    s_mul_i32 s50, s50, 896
    s_add_u32 s64, s64, s50
    s_cmp_ge_u32 s67, 672
    s_cselect_b32 s51, 0x40000000, 0
    v_lshrrev_b32 v128, 3, v1
    v_mul_u32_u24 v128, 2688, v128
    v_and_b32 v129, 7, v1
    v_lshl_add_u32 v128, v129, 4, v128
    v_add_u32 v124, s51, v128
    v_add_u32 v12, s51, v15
    v_lshrrev_b32 v128, 2, v1
    v_mul_u32_u24 v128, 3584, v128
    v_and_b32 v129, 3, v1
    v_lshl_add_u32 v128, v129, 4, v128
    v_add_u32 v125, s51, v128
    s_mov_b32 s20, s6
    s_mov_b32 s21, s7
    s_and_b32 s21, s21, 0xffff
    s_mov_b32 s22, 0x126000
    s_mov_b32 s23, 0x20000
    s_lshl_b32 m0, s38, 11
    s_add_u32 m0, m0, 145920
    s_nop 0
    buffer_load_dwordx4 v124, s[20:23], s64 offen lds
    s_add_u32 m0, m0, 1024
    s_add_u32 s64, s64, 21504
    buffer_load_dwordx4 v124, s[20:23], s64 offen lds
    v_lshrrev_b32 v2, 5, v1
    v_bfe_u32 v5, v1, 2, 2
    v_lshlrev_b32 v7, 10, v2
    v_lshl_add_u32 v7, v5, 6, v7
    v_bfe_u32 v4, v1, 4, 1
    v_and_b32 v6, 3, v1
    v_lshlrev_b32 v6, 3, v6
    v_lshl_add_u32 v5, v2, 3, v5
    v_lshl_add_u32 v128, v5, 7, v6
    v_lshl_add_u32 v128, v4, 5, v128
    s_lshl_b32 s48, s38, 11
    s_add_u32 s49, s48, 145920
    v_add_u32 v120, s49, v128
    v_lshl_add_u32 v128, v5, 6, v6
    v_lshl_add_u32 v128, v4, 10, v128
    s_add_u32 s49, s48, 154112
    v_add_u32 v121, s49, v128
    v_mul_u32_u24 v4, 8224, v4
    v_add3_u32 v7, v7, v4, v6
    v_add_u32 v7, 16384, v7
    v_and_b32 v3, 31, v1
    v_bfe_u32 v4, v1, 1, 3
    v_lshlrev_b32 v3, 7, v3
    v_add_u32 v3, s40, v3
    s_add_u32 s48, s38, 0
    s_and_b32 s48, s48, 3
    s_lshl_b32 s49, s48, 11
    v_add_u32 v104, s49, v7
    s_mul_i32 s49, s48, 3072
    s_add_u32 s49, s49, 66048
    v_add_u32 v196, s49, v15
    s_lshl_b32 s48, s48, 1
    v_add_u32 v5, s48, v2
    v_add_u32 v108, 66048, v104
    v_xor_b32 v5, v5, v4
    v_lshl_add_u32 v96, v5, 4, v3
    v_add_u32 v100, 66048, v96
    s_add_u32 s48, s38, 1
    s_and_b32 s48, s48, 3
    s_lshl_b32 s49, s48, 11
    v_add_u32 v105, s49, v7
    s_mul_i32 s49, s48, 3072
    s_add_u32 s49, s49, 66048
    v_add_u32 v197, s49, v15
    s_lshl_b32 s48, s48, 1
    v_add_u32 v5, s48, v2
    v_add_u32 v109, 66048, v105
    v_xor_b32 v5, v5, v4
    v_lshl_add_u32 v97, v5, 4, v3
    v_add_u32 v101, 66048, v97
    s_add_u32 s48, s38, 2
    s_and_b32 s48, s48, 3
    s_lshl_b32 s49, s48, 11
    v_add_u32 v106, s49, v7
    s_mul_i32 s49, s48, 3072
    s_add_u32 s49, s49, 66048
    v_add_u32 v198, s49, v15
    s_lshl_b32 s48, s48, 1
    v_add_u32 v5, s48, v2
    v_add_u32 v110, 66048, v106
    v_xor_b32 v5, v5, v4
    v_lshl_add_u32 v98, v5, 4, v3
    v_add_u32 v102, 66048, v98
    s_add_u32 s48, s38, 3
    s_and_b32 s48, s48, 3
    s_lshl_b32 s49, s48, 11
    v_add_u32 v107, s49, v7
    s_mul_i32 s49, s48, 3072
    s_add_u32 s49, s49, 66048
    v_add_u32 v199, s49, v15
    s_lshl_b32 s48, s48, 1
    v_add_u32 v5, s48, v2
    v_add_u32 v111, 66048, v107
    v_xor_b32 v5, v5, v4
    v_lshl_add_u32 v99, v5, 4, v3
    v_add_u32 v103, 66048, v99
    s_add_u32 s60, s12, 0xa00000
    s_addc_u32 s61, s13, 0
    s_and_b32 s61, s61, 0xffff
    s_mov_b32 s62, 0x10000
    s_mov_b32 s63, 0x20000
    s_add_u32 s20, s12, 0xa10000
    s_addc_u32 s21, s13, 0
    s_and_b32 s21, s21, 0xffff
    s_mov_b32 s22, 0x2a0000
    s_mov_b32 s23, 0x20000
    s_mov_b32 s47, 0xffff0000
    s_mul_i32 s48, s67, 2731
    s_lshr_b32 s48, s48, 16
    s_mul_i32 s49, s48, 24
    s_sub_u32 s49, s67, s49
    s_lshr_b32 s50, s49, 1
    s_mul_i32 s51, s50, 11
    s_lshr_b32 s51, s51, 5
    s_lshl_b32 s50, s50, 3
    s_lshl_b32 s51, s51, 2
    s_add_u32 s50, s50, s51
    s_and_b32 s49, s49, 1
    s_lshl_b32 s49, s49, 1
    s_add_u32 s50, s50, s49
    s_add_u32 s50, s50, 4
    s_mul_i32 s74, s48, 57344
    s_lshl_b32 s49, s50, 5
    s_add_u32 s74, s74, s49
    s_mul_i32 s48, s67, 2731
    s_lshr_b32 s48, s48, 16
    s_mul_i32 s49, s48, 57344
    s_sub_u32 s49, s74, s49
    s_lshr_b32 s49, s49, 5
    s_mul_i32 s50, s49, 9363
    s_lshr_b32 s50, s50, 16
    s_mul_i32 s51, s50, 7
    s_sub_u32 s49, s49, s51
    s_add_u32 s49, s49, 3
    s_and_b32 s51, s50, 3
    s_sub_u32 s49, s49, s51
    s_sub_u32 s51, s49, 7
    s_cmp_ge_u32 s49, 7
    s_cselect_b32 s49, s51, s49
    s_mul_i32 s50, s50, 28
    s_add_u32 s50, s50, s48
    s_mul_i32 s50, s50, 3
    s_add_u32 s50, s50, s49
    s_lshl_b32 s50, s50, 10
    s_add_u32 s56, s50, 1376256
    s_mul_i32 s48, s67, 2731
    s_lshr_b32 s48, s48, 16
    s_mul_i32 s49, s48, 57344
    s_sub_u32 s49, s74, s49
    s_lshr_b32 s49, s49, 5
    s_add_u32 s49, s49, 1
    s_mul_i32 s50, s49, 9363
    s_lshr_b32 s50, s50, 16
    s_mul_i32 s51, s50, 7
    s_sub_u32 s49, s49, s51
    s_add_u32 s49, s49, 3
    s_and_b32 s51, s50, 3
    s_sub_u32 s49, s49, s51
    s_sub_u32 s51, s49, 7
    s_cmp_ge_u32 s49, 7
    s_cselect_b32 s49, s51, s49
    s_mul_i32 s50, s50, 28
    s_add_u32 s50, s50, s48
    s_mul_i32 s50, s50, 3
    s_add_u32 s50, s50, s49
    s_lshl_b32 s50, s50, 10
    s_add_u32 s57, s50, 1376256
    s_mul_i32 s48, s67, 7282
    s_lshr_b32 s48, s48, 20
    s_mul_i32 s49, s48, 144
    s_sub_u32 s49, s67, s49
    s_sub_u32 s50, s49, 112
    s_lshr_b32 s51, s50, 1
    s_mul_i32 s51, s51, 28
    s_and_b32 s50, s50, 1
    s_lshl_b32 s50, s50, 4
    s_add_u32 s51, s51, s50
    s_mul_i32 s50, s49, 2341
    s_lshr_b32 s50, s50, 16
    s_mul_i32 s50, s50, 28
    s_sub_u32 s65, s49, s50
    s_and_b32 s64, s65, 3
    s_add_u32 s50, s50, s64
    s_and_b32 s64, s65, 12
    s_lshl_b32 s64, s64, 1
    s_add_u32 s50, s50, s64
    s_lshr_b32 s65, s65, 4
    s_lshl_b32 s65, s65, 2
    s_add_u32 s50, s50, s65
    s_lshl_b32 s50, s50, 4
    s_cmp_lt_u32 s49, 112
    s_cselect_b32 s64, s50, s51
    s_cselect_b32 s65, 1, 0
    s_mul_i32 s64, s64, 896
    s_lshl_b32 s48, s48, 7
    s_cmp_ge_u32 s67, 1008
    s_cselect_b32 s51, 0x40000000, 0
    s_add_u32 s48, s48, s51
    v_add_u32 v14, s51, v15
    v_lshrrev_b32 v128, 3, v1
    v_mul_u32_u24 v129, 896, v128
    v_add_u32 v129, s48, v129
    v_bfe_u32 v130, v1, 4, 1
    v_lshlrev_b32 v130, 2, v130
    v_and_b32 v131, 7, v1
    v_xor_b32 v131, v131, v130
    v_lshl_add_u32 v126, v131, 4, v129
    s_mul_i32 s48, s66, 1792
    buffer_load_dwordx4 v[144:147], v169, s[24:27], s48 offen offset:0
    buffer_load_dwordx4 v[148:151], v169, s[24:27], s48 offen offset:896
    v_mov_b32 v26, 14336
    buffer_load_dword v26, v26, s[60:63], 0 offen sc1
    s_add_u32 m0, s40, 33024
    s_nop 0
    buffer_load_dwordx4 v16, s[24:27], s44 offen offset:0 lds
    buffer_load_dwordx4 v17, s[24:27], s44 offen offset:1024 lds
    s_add_u32 m0, s39, 33024
    s_nop 0
    buffer_load_dwordx4 v8, s[16:19], s42 offen offset:0 lds
    buffer_load_dwordx4 v9, s[16:19], s42 offen offset:1024 lds
    v_lshrrev_b32 v128, 5, v1
    v_lshlrev_b32 v128, 2, v128
    v_bfe_u32 v129, v1, 2, 2
    v_add_u32 v128, v128, v129
    v_lshlrev_b32 v128, 7, v128
    v_bfe_u32 v129, v1, 4, 1
    v_lshlrev_b32 v129, 1, v129
    v_bfe_u32 v130, v1, 1, 1
    v_add_u32 v129, v129, v130
    v_bfe_u32 v130, v1, 3, 1
    v_lshlrev_b32 v130, 2, v130
    v_xor_b32 v129, v129, v130
    v_lshl_add_u32 v128, v129, 4, v128
    v_and_b32 v129, 1, v1
    v_lshl_add_u32 v128, v129, 3, v128
    s_lshl_b32 s48, s38, 11
    s_add_u32 s48, s48, 137728
    v_add_u32 v122, s48, v128
    v_xor_b32 v123, 64, v122
    s_add_u32 m0, s40, 33024
    s_nop 0
    buffer_load_dwordx4 v18, s[24:27], s44 offen offset:2048 lds
    buffer_load_dwordx4 v19, s[24:27], s44 offen offset:3072 lds
    s_add_u32 s44, s44, 128
    s_cmp_eq_u32 s58, 6
    s_cselect_b32 s48, 896, 0
    s_sub_u32 s44, s44, s48
    s_mul_i32 s41, s38, 3072
    s_mul_i32 s43, s37, 28
    s_add_u32 s43, s43, s38
    s_lshl_b32 s48, s3, 2
    s_add_u32 s43, s43, s48
    s_mul_i32 s43, s43, 3072
    v_and_b32 v128, 31, v1
    v_lshlrev_b32 v128, 4, v128
    v_add_u32 v226, 132608, v128
    s_lshl_b32 s48, s38, 2
    v_add_u32 v225, s48, v226
    s_add_u32 m0, s39, 33024
    s_nop 0
    buffer_load_dwordx4 v10, s[16:19], s42 offen offset:2048 lds
    buffer_load_dwordx4 v11, s[16:19], s42 offen offset:3072 lds
    s_add_u32 s42, s42, 229376
    s_cmp_eq_u32 s58, 6
    s_cselect_b32 s48, 1605632, 0
    s_sub_u32 s42, s42, s48
    s_add_u32 s58, s58, 1
    s_mov_b32 s28, s12
    s_mov_b32 s29, s13
    s_and_b32 s29, s29, 0xffff
    s_mov_b32 s30, 0x900000
    s_mov_b32 s31, 0x20000
    s_add_u32 s32, s12, 0xcb0000
    s_addc_u32 s33, s13, 0
    s_and_b32 s33, s33, 0xffff
    s_mov_b32 s34, 0x80000
    s_mov_b32 s35, 0x20000
    s_mov_b32 s100, s78
    s_mov_b32 s101, s79
    s_and_b32 s48, s2, 7
    s_lshl_b32 s48, s48, 2
    s_bfe_u32 s49, s2, 0x20003
    s_add_u32 s14, s48, s49
    s_lshr_b32 s15, s2, 5
    v_mov_b32 v21, v15
    v_add_u32 v28, 1024, v15
    s_min_u32 s48, s15, 7
    s_mul_i32 s48, s48, 294912
    s_mul_i32 s49, s38, 57344
    s_add_u32 s81, s48, s49
    s_add_u32 s82, s81, 57344
    s_add_u32 s70, s81, 32768
    s_lshl_b32 s49, s38, 14
    s_add_u32 s83, s48, s49
    s_add_u32 s83, s83, 229376
    s_lshl_b32 s68, s15, 1
    s_and_b32 s49, s14, 3
    s_mul_i32 s50, s49, 3
    s_add_u32 s69, s68, s50
    s_lshl_b32 s49, s49, 2
    s_add_u32 s68, s68, s49
    s_and_b32 s68, s68, 15
    s_sub_u32 s49, s69, 12
    s_cmp_ge_u32 s69, 12
    s_cselect_b32 s69, s49, s69
    s_sub_u32 s49, s69, 12
    s_cmp_ge_u32 s69, 12
    s_cselect_b32 s69, s49, s69
    s_lshl_b32 s49, s68, 11
    s_add_u32 s80, s81, s49
    s_lshl_b32 s49, s69, 11
    s_add_u32 s71, s70, s49
    s_lshl_b32 s48, s36, 2
    s_add_u32 s48, s48, s38
    s_mul_i32 s48, s48, 144
    s_lshr_b32 s49, s37, 2
    s_mul_i32 s49, s49, 28
    s_add_u32 s48, s48, s49
    s_lshl_b32 s45, s48, 10
    s_and_b32 s49, s37, 3
    s_lshl_b32 s50, s49, 12
    s_add_u32 s73, s45, s50
    s_mov_b32 s50, 0x4eb44a30
    s_mov_b32 s51, 0x6f595ed8
    s_lshl_b32 s49, s49, 4
    s_lshr_b64 s[50:51], s[50:51], s49
    s_and_b32 s72, s50, 0x7fff
    s_min_u32 s48, s15, 6
    s_mul_i32 s48, s48, 144
    s_mul_i32 s49, s38, 28
    s_add_u32 s49, s49, s48
    s_lshl_b32 s50, s38, 3
    s_add_u32 s50, s50, s48
    s_add_u32 s50, s50, 84
    v_mov_b32 v227, s49
    v_mov_b32 v128, s50
    v_cmp_gt_u32 vcc, 28, v1
    s_nop 1
    v_cndmask_b32 v227, v128, v227, vcc
    v_min_u32 v128, 35, v1
    v_add_u32 v227, v227, v128
    v_lshlrev_b32 v227, 2, v227
    v_add_u32 v227, 16384, v227
    s_lshl_b32 s48, s37, 8
    s_add_u32 s48, s48, 8192
    v_lshlrev_b32 v27, 2, v1
    v_add_u32 v27, s48, v27
    v_min_u32 v20, 20, v1
    v_mul_u32_u24 v128, 11, v20
    v_lshrrev_b32 v128, 5, v128
    v_mul_u32_u24 v128, 72, v128
    v_lshl_add_u32 v20, v20, 3, v128
    s_mul_i32 s48, s38, 24
    s_lshr_b32 s49, s37, 1
    s_add_u32 s48, s48, s49
    v_add_u32 v20, s48, v20
    v_lshlrev_b32 v20, 2, v20
    v_add_u32 v20, 20480, v20
    s_and_b32 s48, s37, 3
    s_mul_i32 s48, s48, 9
    s_mov_b32 s50, 0x6370a440
    s_mov_b32 s51, 0xb
    s_lshr_b64 s[50:51], s[50:51], s48
    v_min_u32 v30, 20, v1
    v_mul_u32_u24 v128, 11, v30
    v_lshrrev_b32 v128, 5, v128
    v_mul_u32_u24 v30, 3, v30
    v_mad_i32_i24 v30, v128, -9, v30
    v_lshrrev_b32 v30, v30, s50
    v_and_b32 v30, 7, v30
    v_mul_u32_u24 v128, 96, v128
    v_add_u32 v30, v30, v128
    s_mul_i32 s48, s38, 24
    s_lshr_b32 s49, s37, 2
    s_mul_i32 s49, s49, 6
    s_add_u32 s48, s48, s49
    v_add_u32 v30, s48, v30
    v_lshlrev_b32 v30, 2, v30
    v_add_u32 v30, 61440, v30
    v_lshrrev_b32 v2, 2, v1
    v_lshrrev_b32 v3, 4, v1
    v_xor_b32 v2, v2, v3
    v_and_b32 v2, 1, v2
    v_cmp_eq_u32 vcc, 0, v2
    v_mov_b32 v3, 0x3f803f80
    v_mov_b32 v4, 0
    v_cndmask_b32 v3, v4, v3, vcc
    v_accvgpr_write_b32 a160, v3
    v_accvgpr_write_b32 a161, v3
    v_accvgpr_write_b32 a162, v3
    v_accvgpr_write_b32 a163, v3
    v_mov_b32 v209, 0
    v_mov_b32 v210, 0
    v_mov_b32 v211, 0
    v_mov_b32 v213, 0
    v_mov_b32 v214, 0
    v_mov_b32 v215, 0
    v_mov_b32 v205, 0
    v_mov_b32 v206, 0
    v_mov_b32 v207, 0
    s_waitcnt vmcnt(11)
    ds_read_b64_tr_b16 v[112:113], v120 offset:0
    ds_read_b64_tr_b16 v[114:115], v120 offset:512
    ds_read_b64_tr_b16 v[116:117], v120 offset:56
    ds_read_b64_tr_b16 v[118:119], v120 offset:568
    s_waitcnt lgkmcnt(2)
    buffer_store_dwordx4 v[112:115], v12, s[20:23], s46 offen sc1
    s_add_u32 s46, s46, 86016
    s_waitcnt lgkmcnt(0)
    buffer_store_dwordx4 v[116:119], v12, s[20:23], s46 offen sc1
    s_waitcnt vmcnt(10)
    v_readfirstlane_b32 s75, v26
    s_mul_i32 s75, s75, 0x9e3779b1
    s_add_u32 s75, s75, 0x7f4a7c15
    s_barrier
    ds_read_b128 a[0:3], v96 offset:0
    ds_read_b64_tr_b16 a[112:113], v104 offset:0
    ds_read_b64_tr_b16 a[114:115], v104 offset:256
    ds_read_b64_tr_b16 a[116:117], v104 offset:32
    ds_read_b64_tr_b16 a[118:119], v104 offset:288
    ds_read_b64_tr_b16 a[120:121], v104 offset:512
    ds_read_b64_tr_b16 a[122:123], v104 offset:768
    ds_read_b64_tr_b16 a[124:125], v104 offset:544
    ds_read_b64_tr_b16 a[126:127], v104 offset:800
    s_waitcnt lgkmcnt(6)
    v_mfma_f32_32x32x16_bf16 v[32:47], a[112:115], a[0:3], 0
    ds_read_b128 a[4:7], v97 offset:0
    ds_read_b64_tr_b16 a[128:129], v105 offset:0
    ds_read_b64_tr_b16 a[130:131], v105 offset:256
    s_add_u32 m0, s40, 66048
    s_nop 0
    buffer_load_dwordx4 v16, s[24:27], s44 offen offset:0 lds
    v_lshlrev_b32 v160, 16, v144
    v_and_b32 v161, s47, v144
    v_mov_b32 v152, v160
    v_mov_b32 v156, v161
    v_mul_f32 v153, v160, v160
    v_mul_f32 v157, v161, v161
    v_lshlrev_b32 v162, 16, v145
    v_mfma_f32_16x16x32_bf16 a[144:147], a[160:163], a[112:115], 0
    s_waitcnt lgkmcnt(7)
    v_mfma_f32_32x32x16_bf16 v[48:63], a[116:119], a[0:3], 0
    ds_read_b64_tr_b16 a[132:133], v105 offset:32
    ds_read_b64_tr_b16 a[134:135], v105 offset:288
    s_add_u32 m0, s40, 66048
    s_nop 0
    buffer_load_dwordx4 v17, s[24:27], s44 offen offset:1024 lds
    v_and_b32 v163, s47, v145
    v_add_f32 v152, v152, v162
    v_add_f32 v156, v156, v163
    v_fmac_f32 v153, v162, v162
    v_fmac_f32 v157, v163, v163
    v_lshlrev_b32 v160, 16, v146
    v_and_b32 v161, s47, v146
    v_mfma_f32_16x16x32_bf16 a[148:151], a[160:163], a[116:119], 0
    s_waitcnt lgkmcnt(7)
    v_mfma_f32_32x32x16_bf16 v[64:79], a[120:123], a[0:3], 0
    ds_read_b64_tr_b16 a[136:137], v105 offset:512
    ds_read_b64_tr_b16 a[138:139], v105 offset:768
    v_add_f32 v152, v152, v160
    v_add_f32 v156, v156, v161
    v_fmac_f32 v153, v160, v160
    v_fmac_f32 v157, v161, v161
    v_lshlrev_b32 v162, 16, v147
    v_and_b32 v163, s47, v147
    v_add_f32 v152, v152, v162
    v_add_f32 v156, v156, v163
    v_mfma_f32_16x16x32_bf16 a[152:155], a[160:163], a[120:123], 0
    s_waitcnt lgkmcnt(7)
    v_mfma_f32_32x32x16_bf16 v[80:95], a[124:127], a[0:3], 0
    ds_read_b64_tr_b16 a[140:141], v105 offset:544
    ds_read_b64_tr_b16 a[142:143], v105 offset:800
    s_add_u32 m0, s39, 66048
    s_nop 0
    buffer_load_dwordx4 v8, s[16:19], s42 offen offset:0 lds
    v_fmac_f32 v153, v162, v162
    v_fmac_f32 v157, v163, v163
    v_lshlrev_b32 v160, 16, v148
    v_and_b32 v161, s47, v148
    v_mov_b32 v154, v160
    v_mov_b32 v158, v161
    v_mul_f32 v155, v160, v160
    v_mfma_f32_16x16x32_bf16 a[156:159], a[160:163], a[124:127], 0
    s_waitcnt lgkmcnt(6)
    v_mfma_f32_32x32x16_bf16 v[32:47], a[128:131], a[4:7], v[32:47]
    ds_read_b128 a[8:11], v98 offset:0
    ds_read_b64_tr_b16 a[112:113], v106 offset:0
    ds_read_b64_tr_b16 a[114:115], v106 offset:256
    v_mul_f32 v159, v161, v161
    v_lshlrev_b32 v162, 16, v149
    v_and_b32 v163, s47, v149
    v_add_f32 v154, v154, v162
    v_add_f32 v158, v158, v163
    v_fmac_f32 v155, v162, v162
    v_fmac_f32 v159, v163, v163
    s_waitcnt vmcnt(3)
    s_lshl_b32 s48, s67, 2
    s_add_u32 s48, s48, 20480
    v_mov_b32 v2, s48
    v_mov_b32 v3, s75
    s_mov_b64 exec, 1
    buffer_store_dword v3, v2, s[60:63], 0 offen sc1
    s_mov_b64 exec, -1
    s_waitcnt lgkmcnt(7)
    v_mfma_f32_32x32x16_bf16 v[48:63], a[132:135], a[4:7], v[48:63]
    ds_read_b64_tr_b16 a[116:117], v106 offset:32
    ds_read_b64_tr_b16 a[118:119], v106 offset:288
    s_add_u32 m0, s39, 66048
    s_nop 0
    buffer_load_dwordx4 v9, s[16:19], s42 offen offset:1024 lds
    v_lshlrev_b32 v160, 16, v150
    v_and_b32 v161, s47, v150
    v_add_f32 v154, v154, v160
    v_add_f32 v158, v158, v161
    v_fmac_f32 v155, v160, v160
    v_fmac_f32 v159, v161, v161
    v_lshlrev_b32 v162, 16, v151
    s_waitcnt lgkmcnt(7)
    v_mfma_f32_32x32x16_bf16 v[64:79], a[136:139], a[4:7], v[64:79]
    ds_read_b64_tr_b16 a[120:121], v106 offset:512
    ds_read_b64_tr_b16 a[122:123], v106 offset:768
    v_and_b32 v163, s47, v151
    v_add_f32 v154, v154, v162
    v_add_f32 v158, v158, v163
    v_fmac_f32 v155, v162, v162
    v_fmac_f32 v159, v163, v163
    v_add_f32 v152, v152, v156
    v_add_f32 v153, v153, v157
    s_waitcnt lgkmcnt(7)
    v_mfma_f32_32x32x16_bf16 v[80:95], a[140:143], a[4:7], v[80:95]
    ds_read_b64_tr_b16 a[124:125], v106 offset:544
    ds_read_b64_tr_b16 a[126:127], v106 offset:800
    s_add_u32 m0, s40, 66048
    s_nop 0
    buffer_load_dwordx4 v18, s[24:27], s44 offen offset:2048 lds
    v_add_f32 v154, v154, v158
    v_add_f32 v155, v155, v159
    s_nop 0
    v_permlane32_swap_b32 v152, v154
    v_permlane32_swap_b32 v153, v155
    v_add_f32 v152, v152, v154
    v_add_f32 v153, v153, v155
    s_nop 1
    v_permlane16_swap_b32 v152, v153
    s_waitcnt lgkmcnt(6)
    v_mfma_f32_32x32x16_bf16 v[32:47], a[112:115], a[8:11], v[32:47]
    ds_read_b128 a[12:15], v99 offset:0
    ds_read_b64_tr_b16 a[128:129], v107 offset:0
    ds_read_b64_tr_b16 a[130:131], v107 offset:256
    v_add_f32 v152, v152, v153
    s_nop 1
    v_add_f32_dpp v152, v152, v152 quad_perm:[1,0,3,2] row_mask:0xf bank_mask:0xf
    s_nop 1
    v_add_f32_dpp v152, v152, v152 quad_perm:[2,3,0,1] row_mask:0xf bank_mask:0xf
    s_nop 1
    v_add_f32_dpp v152, v152, v152 row_half_mirror row_mask:0xf bank_mask:0xf
    s_nop 1
    v_add_f32_dpp v152, v152, v152 row_mirror row_mask:0xf bank_mask:0xf
    v_mov_b32 v153, v152
    s_nop 1
    v_permlane16_swap_b32 v152, v153
    v_mul_f32 v164, 0x3b124925, v152
    s_mov_b32 s52, s8
    s_and_b32 s53, s9, 0xffff
    s_mov_b32 s54, 1605632
    s_mov_b32 s55, 0x20000
    s_lshl_b32 m0, s38, 11
    s_add_u32 m0, m0, 154112
    s_nop 0
    buffer_load_dwordx4 v125, s[52:55], s74 offen lds
    s_mov_b32 s52, s10
    s_and_b32 s53, s11, 0xffff
    s_mov_b32 s54, 1605632
    s_mov_b32 s55, 0x20000
    s_lshl_b32 m0, s38, 11
    s_add_u32 m0, m0, 155136
    s_nop 0
    buffer_load_dwordx4 v125, s[52:55], s74 offen lds
    s_waitcnt lgkmcnt(7)
    v_mfma_f32_32x32x16_bf16 v[48:63], a[116:119], a[8:11], v[48:63]
    ds_read_b64_tr_b16 a[132:133], v107 offset:32
    ds_read_b64_tr_b16 a[134:135], v107 offset:288
    s_add_u32 m0, s40, 66048
    s_nop 0
    buffer_load_dwordx4 v19, s[24:27], s44 offen offset:3072 lds
    s_add_u32 s44, s44, 128
    s_cmp_eq_u32 s58, 6
    s_cselect_b32 s48, 896, 0
    s_sub_u32 s44, s44, s48
    v_mul_f32 v165, 0x3b124925, v153
    v_fma_f32 v165, -v164, v164, v165
    v_max_f32 v165, 0, v165
    v_cvt_pk_bf16_f32 v165, v165, v165
    v_and_b32 v165, s47, v165
    v_add_f32 v165, 0x3727c5ac, v165
    v_cvt_pk_bf16_f32 v165, v165, v165
    s_waitcnt lgkmcnt(7)
    v_mfma_f32_32x32x16_bf16 v[64:79], a[120:123], a[8:11], v[64:79]
    ds_read_b64_tr_b16 a[136:137], v107 offset:512
    ds_read_b64_tr_b16 a[138:139], v107 offset:768
    v_and_b32 v165, s47, v165
    v_sqrt_f32 v165, v165
    v_xor_b32 v164, 0x80000000, v164
    v_cvt_pk_bf16_f32 v165, v165, v165
    v_and_b32 v165, s47, v165
    v_rcp_f32 v165, v165
    v_cvt_pk_bf16_f32 v164, v164, v164
    s_waitcnt lgkmcnt(7)
    v_mfma_f32_32x32x16_bf16 v[80:95], a[124:127], a[8:11], v[80:95]
    ds_read_b64_tr_b16 a[140:141], v107 offset:544
    ds_read_b64_tr_b16 a[142:143], v107 offset:800
    s_add_u32 m0, s39, 66048
    s_nop 0
    buffer_load_dwordx4 v10, s[16:19], s42 offen offset:2048 lds
    v_lshrrev_b32 v168, 5, v1
    v_lshlrev_b32 v168, 4, v168
    v_readfirstlane_b32 s75, v26
    s_mul_i32 s75, s75, 0x9e3779b1
    s_add_u32 s75, s75, 0x7f4a7c15
    v_mov_b32 v166, s75
    v_mov_b32 v167, s75
    s_waitcnt lgkmcnt(0)
    s_barrier
    v_mfma_f32_32x32x16_bf16 v[32:47], a[128:131], a[12:15], v[32:47]
    ds_read_b128 a[16:19], v96 offset:33024
    ds_read_b64_tr_b16 a[112:113], v104 offset:33024
    ds_read_b64_tr_b16 a[114:115], v104 offset:33280
    s_lshl_b32 s48, s66, 5
    s_add_u32 s48, s48, 24576
    s_mov_b32 exec_lo, 1
    s_mov_b32 exec_hi, 1
    buffer_store_dwordx4 v[164:167], v168, s[60:63], s48 offen sc1
    s_mov_b64 exec, -1
    v_mfma_f32_32x32x16_bf16 v[48:63], a[132:135], a[12:15], v[48:63]
    ds_read_b64_tr_b16 a[116:117], v104 offset:33056
    ds_read_b64_tr_b16 a[118:119], v104 offset:33312
    s_add_u32 m0, s39, 66048
    s_nop 0
    buffer_load_dwordx4 v11, s[16:19], s42 offen offset:3072 lds
    s_add_u32 s42, s42, 229376
    s_cmp_eq_u32 s58, 6
    s_cselect_b32 s48, 1605632, 0
    s_sub_u32 s42, s42, s48
    s_add_u32 s58, s58, 1
    v_mfma_f32_32x32x16_bf16 v[64:79], a[136:139], a[12:15], v[64:79]
    ds_read_b64_tr_b16 a[120:121], v104 offset:33536
    ds_read_b64_tr_b16 a[122:123], v104 offset:33792
    v_mfma_f32_32x32x16_bf16 v[80:95], a[140:143], a[12:15], v[80:95]
    ds_read_b64_tr_b16 a[124:125], v104 offset:33568
    ds_read_b64_tr_b16 a[126:127], v104 offset:33824
    s_add_u32 m0, s40, 99072
    s_nop 0
    buffer_load_dwordx4 v16, s[24:27], s44 offen offset:0 lds
    s_waitcnt lgkmcnt(6)
    v_mfma_f32_32x32x16_bf16 v[32:47], a[112:115], a[16:19], v[32:47]
    ds_read_b128 a[20:23], v97 offset:33024
    ds_read_b64_tr_b16 a[128:129], v105 offset:33024
    ds_read_b64_tr_b16 a[130:131], v105 offset:33280
    v_mfma_f32_16x16x32_bf16 a[144:147], a[160:163], a[112:115], a[144:147]
    s_waitcnt lgkmcnt(7)
    v_mfma_f32_32x32x16_bf16 v[48:63], a[116:119], a[16:19], v[48:63]
    ds_read_b64_tr_b16 a[132:133], v105 offset:33056
    ds_read_b64_tr_b16 a[134:135], v105 offset:33312
    s_add_u32 m0, s40, 99072
    s_nop 0
    buffer_load_dwordx4 v17, s[24:27], s44 offen offset:1024 lds
    v_mfma_f32_16x16x32_bf16 a[148:151], a[160:163], a[116:119], a[148:151]
    s_waitcnt lgkmcnt(7)
    v_mfma_f32_32x32x16_bf16 v[64:79], a[120:123], a[16:19], v[64:79]
    ds_read_b64_tr_b16 a[136:137], v105 offset:33536
    ds_read_b64_tr_b16 a[138:139], v105 offset:33792
    v_mfma_f32_16x16x32_bf16 a[152:155], a[160:163], a[120:123], a[152:155]
    s_waitcnt lgkmcnt(7)
    v_mfma_f32_32x32x16_bf16 v[80:95], a[124:127], a[16:19], v[80:95]
    ds_read_b64_tr_b16 a[140:141], v105 offset:33568
    ds_read_b64_tr_b16 a[142:143], v105 offset:33824
    s_add_u32 m0, s39, 99072
    s_nop 0
    buffer_load_dwordx4 v8, s[16:19], s42 offen offset:0 lds
    v_mfma_f32_16x16x32_bf16 a[156:159], a[160:163], a[124:127], a[156:159]
    s_waitcnt lgkmcnt(6)
    v_mfma_f32_32x32x16_bf16 v[32:47], a[128:131], a[20:23], v[32:47]
    ds_read_b128 a[24:27], v98 offset:33024
    ds_read_b64_tr_b16 a[112:113], v106 offset:33024
    ds_read_b64_tr_b16 a[114:115], v106 offset:33280
    s_add_u32 m0, s39, 99072
    s_nop 0
    buffer_load_dwordx4 v9, s[16:19], s42 offen offset:1024 lds
    s_waitcnt lgkmcnt(7)
    v_mfma_f32_32x32x16_bf16 v[48:63], a[132:135], a[20:23], v[48:63]
    ds_read_b64_tr_b16 a[116:117], v106 offset:33056
    ds_read_b64_tr_b16 a[118:119], v106 offset:33312
    s_waitcnt lgkmcnt(7)
    v_mfma_f32_32x32x16_bf16 v[64:79], a[136:139], a[20:23], v[64:79]
    ds_read_b64_tr_b16 a[120:121], v106 offset:33536
    ds_read_b64_tr_b16 a[122:123], v106 offset:33792
    s_add_u32 m0, s40, 99072
    s_nop 0
    buffer_load_dwordx4 v18, s[24:27], s44 offen offset:2048 lds
    s_waitcnt lgkmcnt(7)
    v_mfma_f32_32x32x16_bf16 v[80:95], a[140:143], a[20:23], v[80:95]
    ds_read_b64_tr_b16 a[124:125], v106 offset:33568
    ds_read_b64_tr_b16 a[126:127], v106 offset:33824
    s_waitcnt lgkmcnt(6)
    v_mfma_f32_32x32x16_bf16 v[32:47], a[112:115], a[24:27], v[32:47]
    ds_read_b128 a[28:31], v99 offset:33024
    ds_read_b64_tr_b16 a[128:129], v107 offset:33024
    ds_read_b64_tr_b16 a[130:131], v107 offset:33280
    s_add_u32 m0, s40, 99072
    s_nop 0
    buffer_load_dwordx4 v19, s[24:27], s44 offen offset:3072 lds
    s_add_u32 s44, s44, 128
    s_cmp_eq_u32 s58, 6
    s_cselect_b32 s48, 896, 0
    s_sub_u32 s44, s44, s48
    s_waitcnt lgkmcnt(7)
    v_mfma_f32_32x32x16_bf16 v[48:63], a[116:119], a[24:27], v[48:63]
    ds_read_b64_tr_b16 a[132:133], v107 offset:33056
    ds_read_b64_tr_b16 a[134:135], v107 offset:33312
    s_waitcnt lgkmcnt(7)
    v_mfma_f32_32x32x16_bf16 v[64:79], a[120:123], a[24:27], v[64:79]
    ds_read_b64_tr_b16 a[136:137], v107 offset:33536
    ds_read_b64_tr_b16 a[138:139], v107 offset:33792
    s_add_u32 m0, s39, 99072
    s_nop 0
    buffer_load_dwordx4 v10, s[16:19], s42 offen offset:2048 lds
    s_waitcnt lgkmcnt(7)
    v_mfma_f32_32x32x16_bf16 v[80:95], a[124:127], a[24:27], v[80:95]
    ds_read_b64_tr_b16 a[140:141], v107 offset:33568
    ds_read_b64_tr_b16 a[142:143], v107 offset:33824
    s_waitcnt vmcnt(7) lgkmcnt(0)
    s_barrier
    v_mfma_f32_32x32x16_bf16 v[32:47], a[128:131], a[28:31], v[32:47]
    ds_read_b128 a[32:35], v100 offset:0
    ds_read_b64_tr_b16 a[112:113], v108 offset:0
    ds_read_b64_tr_b16 a[114:115], v108 offset:256
    s_add_u32 m0, s39, 99072
    s_nop 0
    buffer_load_dwordx4 v11, s[16:19], s42 offen offset:3072 lds
    s_add_u32 s42, s42, 229376
    s_cmp_eq_u32 s58, 6
    s_cselect_b32 s48, 1605632, 0
    s_sub_u32 s42, s42, s48
    s_add_u32 s58, s58, 1
    v_mfma_f32_32x32x16_bf16 v[48:63], a[132:135], a[28:31], v[48:63]
    ds_read_b64_tr_b16 a[116:117], v108 offset:32
    ds_read_b64_tr_b16 a[118:119], v108 offset:288
    v_mfma_f32_32x32x16_bf16 v[64:79], a[136:139], a[28:31], v[64:79]
    ds_read_b64_tr_b16 a[120:121], v108 offset:512
    ds_read_b64_tr_b16 a[122:123], v108 offset:768
    s_add_u32 m0, s40, 0
    s_nop 0
    buffer_load_dwordx4 v16, s[24:27], s44 offen offset:0 lds
    v_mfma_f32_32x32x16_bf16 v[80:95], a[140:143], a[28:31], v[80:95]
    ds_read_b64_tr_b16 a[124:125], v108 offset:544
    ds_read_b64_tr_b16 a[126:127], v108 offset:800
    s_waitcnt lgkmcnt(6)
    v_mfma_f32_32x32x16_bf16 v[32:47], a[112:115], a[32:35], v[32:47]
    ds_read_b128 a[36:39], v101 offset:0
    ds_read_b64_tr_b16 a[128:129], v109 offset:0
    ds_read_b64_tr_b16 a[130:131], v109 offset:256
    s_add_u32 m0, s40, 0
    s_nop 0
    buffer_load_dwordx4 v17, s[24:27], s44 offen offset:1024 lds
    s_cmp_lg_u32 s65, 0
    s_cselect_b32 s52, s76, s98
    s_cselect_b32 s53, s77, s99
    s_mov_b32 s54, 401408
    s_cselect_b32 s54, 1605632, s54
    s_and_b32 s53, s53, 0xffff
    s_mov_b32 s55, 0x20000
    s_lshl_b32 m0, s38, 11
    s_add_u32 m0, m0, 137728
    s_nop 0
    buffer_load_dwordx4 v126, s[52:55], s64 offen lds
    s_add_u32 m0, m0, 1024
    s_add_u32 s64, s64, 7168
    buffer_load_dwordx4 v126, s[52:55], s64 offen lds
    v_mfma_f32_16x16x32_bf16 a[144:147], a[160:163], a[112:115], a[144:147]
    s_add_u32 s76, s12, 0xd30000
    s_addc_u32 s77, s13, 0
    s_and_b32 s77, s77, 0xffff
    s_mov_b32 s78, 0x1f8000
    s_mov_b32 s79, 0x20000
    s_waitcnt lgkmcnt(7)
    v_mfma_f32_32x32x16_bf16 v[48:63], a[116:119], a[32:35], v[48:63]
    ds_read_b64_tr_b16 a[132:133], v109 offset:32
    ds_read_b64_tr_b16 a[134:135], v109 offset:288
    v_mfma_f32_16x16x32_bf16 a[148:151], a[160:163], a[116:119], a[148:151]
    s_waitcnt lgkmcnt(7)
    v_mfma_f32_32x32x16_bf16 v[64:79], a[120:123], a[32:35], v[64:79]
    ds_read_b64_tr_b16 a[136:137], v109 offset:512
    ds_read_b64_tr_b16 a[138:139], v109 offset:768
    s_add_u32 m0, s39, 0
    s_nop 0
    buffer_load_dwordx4 v8, s[16:19], s42 offen offset:0 lds
    v_mfma_f32_16x16x32_bf16 a[152:155], a[160:163], a[120:123], a[152:155]
    s_waitcnt lgkmcnt(7)
    v_mfma_f32_32x32x16_bf16 v[80:95], a[124:127], a[32:35], v[80:95]
    ds_read_b64_tr_b16 a[140:141], v109 offset:544
    ds_read_b64_tr_b16 a[142:143], v109 offset:800
    v_mfma_f32_16x16x32_bf16 a[156:159], a[160:163], a[124:127], a[156:159]
    s_waitcnt lgkmcnt(6)
    v_mfma_f32_32x32x16_bf16 v[32:47], a[128:131], a[36:39], v[32:47]
    ds_read_b128 a[40:43], v102 offset:0
    ds_read_b64_tr_b16 a[112:113], v110 offset:0
    ds_read_b64_tr_b16 a[114:115], v110 offset:256
    s_add_u32 m0, s39, 0
    s_nop 0
    buffer_load_dwordx4 v9, s[16:19], s42 offen offset:1024 lds
    ds_read_b64_tr_b16 v[112:113], v121 offset:0
    ds_read_b64_tr_b16 v[114:115], v121 offset:256
    ds_read_b64_tr_b16 v[116:117], v121 offset:32
    ds_read_b64_tr_b16 v[118:119], v121 offset:288
    s_waitcnt lgkmcnt(11)
    v_mfma_f32_32x32x16_bf16 v[48:63], a[132:135], a[36:39], v[48:63]
    ds_read_b64_tr_b16 a[116:117], v110 offset:32
    ds_read_b64_tr_b16 a[118:119], v110 offset:288
    s_waitcnt lgkmcnt(11)
    v_mfma_f32_32x32x16_bf16 v[64:79], a[136:139], a[36:39], v[64:79]
    ds_read_b64_tr_b16 a[120:121], v110 offset:512
    ds_read_b64_tr_b16 a[122:123], v110 offset:768
    s_add_u32 m0, s40, 0
    s_nop 0
    buffer_load_dwordx4 v18, s[24:27], s44 offen offset:2048 lds
    s_waitcnt lgkmcnt(11)
    v_mfma_f32_32x32x16_bf16 v[80:95], a[140:143], a[36:39], v[80:95]
    ds_read_b64_tr_b16 a[124:125], v110 offset:544
    ds_read_b64_tr_b16 a[126:127], v110 offset:800
    s_add_u32 m0, s40, 0
    s_nop 0
    buffer_load_dwordx4 v19, s[24:27], s44 offen offset:3072 lds
    s_add_u32 s44, s44, 128
    s_cmp_eq_u32 s58, 6
    s_cselect_b32 s48, 896, 0
    s_sub_u32 s44, s44, s48
    s_waitcnt lgkmcnt(10)
    v_mfma_f32_32x32x16_bf16 v[32:47], a[112:115], a[40:43], v[32:47]
    ds_read_b128 a[44:47], v103 offset:0
    ds_read_b64_tr_b16 a[128:129], v111 offset:0
    ds_read_b64_tr_b16 a[130:131], v111 offset:256
    s_waitcnt lgkmcnt(11)
    buffer_store_dwordx4 v[112:115], v12, s[20:23], s56 offen sc1
    s_waitcnt lgkmcnt(9)
    buffer_store_dwordx4 v[116:119], v12, s[20:23], s57 offen sc1
    s_waitcnt lgkmcnt(7)
    v_mfma_f32_32x32x16_bf16 v[48:63], a[116:119], a[40:43], v[48:63]
    ds_read_b64_tr_b16 a[132:133], v111 offset:32
    ds_read_b64_tr_b16 a[134:135], v111 offset:288
    s_add_u32 m0, s39, 0
    s_nop 0
    buffer_load_dwordx4 v10, s[16:19], s42 offen offset:2048 lds
    s_waitcnt lgkmcnt(7)
    v_mfma_f32_32x32x16_bf16 v[64:79], a[120:123], a[40:43], v[64:79]
    ds_read_b64_tr_b16 a[136:137], v111 offset:512
    ds_read_b64_tr_b16 a[138:139], v111 offset:768
    s_waitcnt lgkmcnt(7)
    v_mfma_f32_32x32x16_bf16 v[80:95], a[124:127], a[40:43], v[80:95]
    ds_read_b64_tr_b16 a[140:141], v111 offset:544
    ds_read_b64_tr_b16 a[142:143], v111 offset:800
    s_add_u32 m0, s39, 0
    s_nop 0
    buffer_load_dwordx4 v11, s[16:19], s42 offen offset:3072 lds
    s_add_u32 s42, s42, 229376
    s_cmp_eq_u32 s58, 6
    s_cselect_b32 s48, 1605632, 0
    s_sub_u32 s42, s42, s48
    s_add_u32 s58, s58, 1
    s_waitcnt vmcnt(12) lgkmcnt(0)
    s_barrier
    v_mfma_f32_32x32x16_bf16 v[32:47], a[128:131], a[44:47], v[32:47]
    ds_read_b128 a[48:51], v100 offset:33024
    ds_read_b64_tr_b16 a[112:113], v108 offset:33024
    ds_read_b64_tr_b16 a[114:115], v108 offset:33280
    v_mfma_f32_32x32x16_bf16 v[48:63], a[132:135], a[44:47], v[48:63]
    ds_read_b64_tr_b16 a[116:117], v108 offset:33056
    ds_read_b64_tr_b16 a[118:119], v108 offset:33312
    s_add_u32 m0, s40, 33024
    s_nop 0
    buffer_load_dwordx4 v16, s[24:27], s44 offen offset:0 lds
    buffer_load_dword v20, v20, s[60:63], 0 offen sc1
    v_mfma_f32_32x32x16_bf16 v[64:79], a[136:139], a[44:47], v[64:79]
    ds_read_b64_tr_b16 a[120:121], v108 offset:33536
    ds_read_b64_tr_b16 a[122:123], v108 offset:33792
    v_mfma_f32_32x32x16_bf16 v[80:95], a[140:143], a[44:47], v[80:95]
    ds_read_b64_tr_b16 a[124:125], v108 offset:33568
    ds_read_b64_tr_b16 a[126:127], v108 offset:33824
    s_add_u32 m0, s40, 33024
    s_nop 0
    buffer_load_dwordx4 v17, s[24:27], s44 offen offset:1024 lds
    s_waitcnt lgkmcnt(6)
    v_mfma_f32_32x32x16_bf16 v[32:47], a[112:115], a[48:51], v[32:47]
    ds_read_b128 a[52:55], v101 offset:33024
    ds_read_b64_tr_b16 a[128:129], v109 offset:33024
    ds_read_b64_tr_b16 a[130:131], v109 offset:33280
    v_mfma_f32_16x16x32_bf16 a[144:147], a[160:163], a[112:115], a[144:147]
    s_waitcnt lgkmcnt(7)
    v_mfma_f32_32x32x16_bf16 v[48:63], a[116:119], a[48:51], v[48:63]
    ds_read_b64_tr_b16 a[132:133], v109 offset:33056
    ds_read_b64_tr_b16 a[134:135], v109 offset:33312
    s_add_u32 m0, s39, 33024
    s_nop 0
    buffer_load_dwordx4 v8, s[16:19], s42 offen offset:0 lds
    v_mfma_f32_16x16x32_bf16 a[148:151], a[160:163], a[116:119], a[148:151]
    s_waitcnt lgkmcnt(7)
    v_mfma_f32_32x32x16_bf16 v[64:79], a[120:123], a[48:51], v[64:79]
    ds_read_b64_tr_b16 a[136:137], v109 offset:33536
    ds_read_b64_tr_b16 a[138:139], v109 offset:33792
    v_mfma_f32_16x16x32_bf16 a[152:155], a[160:163], a[120:123], a[152:155]
    s_waitcnt lgkmcnt(7)
    v_mfma_f32_32x32x16_bf16 v[80:95], a[124:127], a[48:51], v[80:95]
    ds_read_b64_tr_b16 a[140:141], v109 offset:33568
    ds_read_b64_tr_b16 a[142:143], v109 offset:33824
    s_add_u32 m0, s39, 33024
    s_nop 0
    buffer_load_dwordx4 v9, s[16:19], s42 offen offset:1024 lds
    v_mfma_f32_16x16x32_bf16 a[156:159], a[160:163], a[124:127], a[156:159]
    s_waitcnt lgkmcnt(6)
    v_mfma_f32_32x32x16_bf16 v[32:47], a[128:131], a[52:55], v[32:47]
    ds_read_b128 a[56:59], v102 offset:33024
    ds_read_b64_tr_b16 a[112:113], v110 offset:33024
    ds_read_b64_tr_b16 a[114:115], v110 offset:33280
    s_waitcnt lgkmcnt(7)
    v_mfma_f32_32x32x16_bf16 v[48:63], a[132:135], a[52:55], v[48:63]
    ds_read_b64_tr_b16 a[116:117], v110 offset:33056
    ds_read_b64_tr_b16 a[118:119], v110 offset:33312
    s_add_u32 m0, s40, 33024
    s_nop 0
    buffer_load_dwordx4 v18, s[24:27], s44 offen offset:2048 lds
    s_waitcnt lgkmcnt(7)
    v_mfma_f32_32x32x16_bf16 v[64:79], a[136:139], a[52:55], v[64:79]
    ds_read_b64_tr_b16 a[120:121], v110 offset:33536
    ds_read_b64_tr_b16 a[122:123], v110 offset:33792
    s_waitcnt lgkmcnt(7)
    v_mfma_f32_32x32x16_bf16 v[80:95], a[140:143], a[52:55], v[80:95]
    ds_read_b64_tr_b16 a[124:125], v110 offset:33568
    ds_read_b64_tr_b16 a[126:127], v110 offset:33824
    s_add_u32 m0, s40, 33024
    s_nop 0
    buffer_load_dwordx4 v19, s[24:27], s44 offen offset:3072 lds
    s_add_u32 s44, s44, 128
    s_cmp_eq_u32 s58, 6
    s_cselect_b32 s48, 896, 0
    s_sub_u32 s44, s44, s48
    s_waitcnt lgkmcnt(6)
    v_mfma_f32_32x32x16_bf16 v[32:47], a[112:115], a[56:59], v[32:47]
    ds_read_b128 a[60:63], v103 offset:33024
    ds_read_b64_tr_b16 a[128:129], v111 offset:33024
    ds_read_b64_tr_b16 a[130:131], v111 offset:33280
    s_add_u32 m0, s39, 33024
    s_nop 0
    buffer_load_dwordx4 v10, s[16:19], s42 offen offset:2048 lds
    s_waitcnt lgkmcnt(7)
    v_mfma_f32_32x32x16_bf16 v[48:63], a[116:119], a[56:59], v[48:63]
    ds_read_b64_tr_b16 a[132:133], v111 offset:33056
    ds_read_b64_tr_b16 a[134:135], v111 offset:33312
    s_waitcnt lgkmcnt(7)
    v_mfma_f32_32x32x16_bf16 v[64:79], a[120:123], a[56:59], v[64:79]
    ds_read_b64_tr_b16 a[136:137], v111 offset:33536
    ds_read_b64_tr_b16 a[138:139], v111 offset:33792
    s_add_u32 m0, s39, 33024
    s_nop 0
    buffer_load_dwordx4 v11, s[16:19], s42 offen offset:3072 lds
    s_add_u32 s42, s42, 229376
    s_cmp_eq_u32 s58, 6
    s_cselect_b32 s48, 1605632, 0
    s_sub_u32 s42, s42, s48
    s_add_u32 s58, s58, 1
    s_waitcnt lgkmcnt(7)
    v_mfma_f32_32x32x16_bf16 v[80:95], a[124:127], a[56:59], v[80:95]
    ds_read_b64_tr_b16 a[140:141], v111 offset:33568
    ds_read_b64_tr_b16 a[142:143], v111 offset:33824
    s_waitcnt vmcnt(9) lgkmcnt(0)
    s_barrier
    v_mfma_f32_32x32x16_bf16 v[32:47], a[128:131], a[60:63], v[32:47]
    ds_read_b128 a[64:67], v96 offset:0
    ds_read_b64_tr_b16 a[112:113], v104 offset:0
    ds_read_b64_tr_b16 a[114:115], v104 offset:256
    s_add_u32 m0, s40, 66048
    s_nop 0
    buffer_load_dwordx4 v16, s[24:27], s44 offen offset:0 lds
    ds_read_b64_tr_b16 v[112:113], v122 offset:0
    ds_read_b64_tr_b16 v[114:115], v122 offset:1024
    ds_read_b64_tr_b16 v[116:117], v123 offset:0
    ds_read_b64_tr_b16 v[118:119], v123 offset:1024
    s_lshl_b32 s48, s67, 2
    s_add_u32 s48, s48, 61440
    v_mov_b32 v2, s48
    v_mov_b32 v3, s75
    s_mov_b64 exec, 1
    buffer_store_dword v3, v2, s[60:63], 0 offen sc1
    s_mov_b64 exec, -1
    v_mfma_f32_32x32x16_bf16 v[48:63], a[132:135], a[60:63], v[48:63]
    ds_read_b64_tr_b16 a[116:117], v104 offset:32
    ds_read_b64_tr_b16 a[118:119], v104 offset:288
    v_mfma_f32_32x32x16_bf16 v[64:79], a[136:139], a[60:63], v[64:79]
    ds_read_b64_tr_b16 a[120:121], v104 offset:512
    ds_read_b64_tr_b16 a[122:123], v104 offset:768
    s_add_u32 m0, s40, 66048
    s_nop 0
    buffer_load_dwordx4 v17, s[24:27], s44 offen offset:1024 lds
    v_mfma_f32_32x32x16_bf16 v[80:95], a[140:143], a[60:63], v[80:95]
    ds_read_b64_tr_b16 a[124:125], v104 offset:544
    ds_read_b64_tr_b16 a[126:127], v104 offset:800
    s_waitcnt lgkmcnt(10)
    v_mfma_f32_32x32x16_bf16 v[32:47], a[112:115], a[64:67], v[32:47]
    ds_read_b128 a[68:71], v97 offset:0
    ds_read_b64_tr_b16 a[128:129], v105 offset:0
    ds_read_b64_tr_b16 a[130:131], v105 offset:256
    s_add_u32 m0, s39, 66048
    s_nop 0
    buffer_load_dwordx4 v8, s[16:19], s42 offen offset:0 lds
    s_lshl_b32 s48, s67, 11
    s_waitcnt lgkmcnt(11)
    buffer_store_dwordx4 v[112:115], v14, s[76:79], s48 offen offset:0 sc1
    s_waitcnt lgkmcnt(9)
    buffer_store_dwordx4 v[116:119], v14, s[76:79], s48 offen offset:1024 sc1
    v_mfma_f32_16x16x32_bf16 a[144:147], a[160:163], a[112:115], a[144:147]
    s_waitcnt lgkmcnt(7)
    v_mfma_f32_32x32x16_bf16 v[48:63], a[116:119], a[64:67], v[48:63]
    ds_read_b64_tr_b16 a[132:133], v105 offset:32
    ds_read_b64_tr_b16 a[134:135], v105 offset:288
    v_mfma_f32_16x16x32_bf16 a[148:151], a[160:163], a[116:119], a[148:151]
    s_waitcnt lgkmcnt(7)
    v_mfma_f32_32x32x16_bf16 v[64:79], a[120:123], a[64:67], v[64:79]
    ds_read_b64_tr_b16 a[136:137], v105 offset:512
    ds_read_b64_tr_b16 a[138:139], v105 offset:768
    s_add_u32 m0, s39, 66048
    s_nop 0
    buffer_load_dwordx4 v9, s[16:19], s42 offen offset:1024 lds
    v_mfma_f32_16x16x32_bf16 a[152:155], a[160:163], a[120:123], a[152:155]
    s_waitcnt lgkmcnt(7)
    v_mfma_f32_32x32x16_bf16 v[80:95], a[124:127], a[64:67], v[80:95]
    ds_read_b64_tr_b16 a[140:141], v105 offset:544
    ds_read_b64_tr_b16 a[142:143], v105 offset:800
    v_mfma_f32_16x16x32_bf16 a[156:159], a[160:163], a[124:127], a[156:159]
    s_waitcnt lgkmcnt(6)
    v_mfma_f32_32x32x16_bf16 v[32:47], a[128:131], a[68:71], v[32:47]
    ds_read_b128 a[72:75], v98 offset:0
    ds_read_b64_tr_b16 a[112:113], v106 offset:0
    ds_read_b64_tr_b16 a[114:115], v106 offset:256
    s_add_u32 m0, s40, 66048
    s_nop 0
    buffer_load_dwordx4 v18, s[24:27], s44 offen offset:2048 lds
    s_waitcnt lgkmcnt(7)
    v_mfma_f32_32x32x16_bf16 v[48:63], a[132:135], a[68:71], v[48:63]
    ds_read_b64_tr_b16 a[116:117], v106 offset:32
    ds_read_b64_tr_b16 a[118:119], v106 offset:288
    s_waitcnt lgkmcnt(7)
    v_mfma_f32_32x32x16_bf16 v[64:79], a[136:139], a[68:71], v[64:79]
    ds_read_b64_tr_b16 a[120:121], v106 offset:512
    ds_read_b64_tr_b16 a[122:123], v106 offset:768
    s_add_u32 m0, s40, 66048
    s_nop 0
    buffer_load_dwordx4 v19, s[24:27], s44 offen offset:3072 lds
    s_waitcnt lgkmcnt(7)
    v_mfma_f32_32x32x16_bf16 v[80:95], a[140:143], a[68:71], v[80:95]
    ds_read_b64_tr_b16 a[124:125], v106 offset:544
    ds_read_b64_tr_b16 a[126:127], v106 offset:800
    s_waitcnt lgkmcnt(6)
    v_mfma_f32_32x32x16_bf16 v[32:47], a[112:115], a[72:75], v[32:47]
    ds_read_b128 a[76:79], v99 offset:0
    ds_read_b64_tr_b16 a[128:129], v107 offset:0
    ds_read_b64_tr_b16 a[130:131], v107 offset:256
    s_add_u32 m0, s39, 66048
    s_nop 0
    buffer_load_dwordx4 v10, s[16:19], s42 offen offset:2048 lds
    v_and_b32 v2, 31, v1
    v_lshlrev_b32 v2, 4, v2
    s_lshl_b32 s48, s36, 2
    s_add_u32 s48, s48, s38
    s_lshl_b32 s48, s48, 9
    s_add_u32 s48, s48, 24576
    buffer_load_dwordx4 v[22:25], v2, s[60:63], s48 offen sc1
    s_waitcnt lgkmcnt(7)
    v_mfma_f32_32x32x16_bf16 v[48:63], a[116:119], a[72:75], v[48:63]
    ds_read_b64_tr_b16 a[132:133], v107 offset:32
    ds_read_b64_tr_b16 a[134:135], v107 offset:288
    s_waitcnt lgkmcnt(7)
    v_mfma_f32_32x32x16_bf16 v[64:79], a[120:123], a[72:75], v[64:79]
    ds_read_b64_tr_b16 a[136:137], v107 offset:512
    ds_read_b64_tr_b16 a[138:139], v107 offset:768
    s_add_u32 m0, s39, 66048
    s_nop 0
    buffer_load_dwordx4 v11, s[16:19], s42 offen offset:3072 lds
    s_waitcnt lgkmcnt(7)
    v_mfma_f32_32x32x16_bf16 v[80:95], a[124:127], a[72:75], v[80:95]
    ds_read_b64_tr_b16 a[140:141], v107 offset:544
    ds_read_b64_tr_b16 a[142:143], v107 offset:800
    s_waitcnt vmcnt(19)
    v_cmp_ne_u32 vcc, s75, v20
    s_nop 0
    s_cbranch_vccnz L_slowP_1
L_okP_2:
    s_waitcnt vmcnt(12) lgkmcnt(0)
    s_barrier
    v_mfma_f32_32x32x16_bf16 v[32:47], a[128:131], a[76:79], v[32:47]
    ds_read_b128 a[80:83], v96 offset:33024
    ds_read_b64_tr_b16 a[112:113], v104 offset:33024
    ds_read_b64_tr_b16 a[114:115], v104 offset:33280
    s_add_u32 m0, s41, 99072
    s_nop 0
    buffer_load_dwordx4 v15, s[20:23], s43 offen offset:0 lds
    v_mfma_f32_32x32x16_bf16 v[48:63], a[132:135], a[76:79], v[48:63]
    ds_read_b64_tr_b16 a[116:117], v104 offset:33056
    ds_read_b64_tr_b16 a[118:119], v104 offset:33312
    v_mfma_f32_32x32x16_bf16 v[64:79], a[136:139], a[76:79], v[64:79]
    ds_read_b64_tr_b16 a[120:121], v104 offset:33536
    ds_read_b64_tr_b16 a[122:123], v104 offset:33792
    v_mfma_f32_32x32x16_bf16 v[80:95], a[140:143], a[76:79], v[80:95]
    ds_read_b64_tr_b16 a[124:125], v104 offset:33568
    ds_read_b64_tr_b16 a[126:127], v104 offset:33824
    s_waitcnt lgkmcnt(6)
    v_mfma_f32_32x32x16_bf16 v[32:47], a[112:115], a[80:83], v[32:47]
    ds_read_b128 a[84:87], v97 offset:33024
    ds_read_b64_tr_b16 a[128:129], v105 offset:33024
    ds_read_b64_tr_b16 a[130:131], v105 offset:33280
    buffer_load_dwordx4 v15, s[20:23], s43 offen offset:1024 lds
    v_mfma_f32_16x16x32_bf16 a[144:147], a[160:163], a[112:115], a[144:147]
    s_waitcnt lgkmcnt(7)
    v_mfma_f32_32x32x16_bf16 v[48:63], a[116:119], a[80:83], v[48:63]
    ds_read_b64_tr_b16 a[132:133], v105 offset:33056
    ds_read_b64_tr_b16 a[134:135], v105 offset:33312
    v_mfma_f32_16x16x32_bf16 a[148:151], a[160:163], a[116:119], a[148:151]
    s_waitcnt lgkmcnt(7)
    v_mfma_f32_32x32x16_bf16 v[64:79], a[120:123], a[80:83], v[64:79]
    ds_read_b64_tr_b16 a[136:137], v105 offset:33536
    ds_read_b64_tr_b16 a[138:139], v105 offset:33792
    buffer_load_dwordx4 v15, s[20:23], s43 offen offset:2048 lds
    s_add_u32 s43, s43, 12288
    s_cmp_eq_u32 s59, 6
    s_cselect_b32 s48, 86016, 0
    s_sub_u32 s43, s43, s48
    s_add_u32 s59, s59, 1
    s_add_u32 m0, s41, 115584
    v_mfma_f32_16x16x32_bf16 a[152:155], a[160:163], a[120:123], a[152:155]
    s_waitcnt lgkmcnt(7)
    v_mfma_f32_32x32x16_bf16 v[80:95], a[124:127], a[80:83], v[80:95]
    ds_read_b64_tr_b16 a[140:141], v105 offset:33568
    ds_read_b64_tr_b16 a[142:143], v105 offset:33824
    buffer_load_dwordx4 v15, s[20:23], s43 offen offset:0 lds
    v_mfma_f32_16x16x32_bf16 a[156:159], a[160:163], a[124:127], a[156:159]
    s_waitcnt lgkmcnt(6)
    v_mfma_f32_32x32x16_bf16 v[32:47], a[128:131], a[84:87], v[32:47]
    ds_read_b128 a[88:91], v98 offset:33024
    ds_read_b64_tr_b16 a[112:113], v106 offset:33024
    ds_read_b64_tr_b16 a[114:115], v106 offset:33280
    s_waitcnt lgkmcnt(7)
    v_mfma_f32_32x32x16_bf16 v[48:63], a[132:135], a[84:87], v[48:63]
    ds_read_b64_tr_b16 a[116:117], v106 offset:33056
    ds_read_b64_tr_b16 a[118:119], v106 offset:33312
    s_waitcnt lgkmcnt(7)
    v_mfma_f32_32x32x16_bf16 v[64:79], a[136:139], a[84:87], v[64:79]
    ds_read_b64_tr_b16 a[120:121], v106 offset:33536
    ds_read_b64_tr_b16 a[122:123], v106 offset:33792
    buffer_load_dwordx4 v15, s[20:23], s43 offen offset:1024 lds
    s_waitcnt lgkmcnt(7)
    v_mfma_f32_32x32x16_bf16 v[80:95], a[140:143], a[84:87], v[80:95]
    ds_read_b64_tr_b16 a[124:125], v106 offset:33568
    ds_read_b64_tr_b16 a[126:127], v106 offset:33824
    s_waitcnt lgkmcnt(6)
    v_mfma_f32_32x32x16_bf16 v[32:47], a[112:115], a[88:91], v[32:47]
    ds_read_b128 a[92:95], v99 offset:33024
    ds_read_b64_tr_b16 a[128:129], v107 offset:33024
    ds_read_b64_tr_b16 a[130:131], v107 offset:33280
    s_waitcnt vmcnt(11)
    s_lshl_b32 s48, s67, 2
    s_add_u32 s48, s48, 16384
    v_mov_b32 v2, s48
    v_mov_b32 v3, s75
    s_mov_b64 exec, 1
    buffer_store_dword v3, v2, s[60:63], 0 offen sc1
    s_mov_b64 exec, -1
    s_waitcnt lgkmcnt(7)
    v_mfma_f32_32x32x16_bf16 v[48:63], a[116:119], a[88:91], v[48:63]
    ds_read_b64_tr_b16 a[132:133], v107 offset:33056
    ds_read_b64_tr_b16 a[134:135], v107 offset:33312
    s_waitcnt lgkmcnt(7)
    v_mfma_f32_32x32x16_bf16 v[64:79], a[120:123], a[88:91], v[64:79]
    ds_read_b64_tr_b16 a[136:137], v107 offset:33536
    ds_read_b64_tr_b16 a[138:139], v107 offset:33792
    buffer_load_dwordx4 v15, s[20:23], s43 offen offset:2048 lds
    s_add_u32 s43, s43, 12288
    s_cmp_eq_u32 s59, 6
    s_cselect_b32 s48, 86016, 0
    s_sub_u32 s43, s43, s48
    s_add_u32 s59, s59, 1
    s_add_u32 m0, s41, 0
    s_waitcnt lgkmcnt(7)
    v_mfma_f32_32x32x16_bf16 v[80:95], a[124:127], a[88:91], v[80:95]
    ds_read_b64_tr_b16 a[140:141], v107 offset:33568
    ds_read_b64_tr_b16 a[142:143], v107 offset:33824
    buffer_load_dwordx4 v15, s[20:23], s43 offen offset:0 lds
    s_waitcnt vmcnt(8) lgkmcnt(0)
    s_barrier
    v_mfma_f32_32x32x16_bf16 v[32:47], a[128:131], a[92:95], v[32:47]
    ds_read_b128 a[96:99], v100 offset:0
    ds_read_b64_tr_b16 a[112:113], v108 offset:0
    ds_read_b64_tr_b16 a[114:115], v108 offset:256
    v_mfma_f32_32x32x16_bf16 v[48:63], a[132:135], a[92:95], v[48:63]
    ds_read_b64_tr_b16 a[116:117], v108 offset:32
    ds_read_b64_tr_b16 a[118:119], v108 offset:288
    v_mfma_f32_32x32x16_bf16 v[64:79], a[136:139], a[92:95], v[64:79]
    ds_read_b64_tr_b16 a[120:121], v108 offset:512
    ds_read_b64_tr_b16 a[122:123], v108 offset:768
    v_mfma_f32_32x32x16_bf16 v[80:95], a[140:143], a[92:95], v[80:95]
    ds_read_b64_tr_b16 a[124:125], v108 offset:544
    ds_read_b64_tr_b16 a[126:127], v108 offset:800
    buffer_load_dwordx4 v15, s[20:23], s43 offen offset:1024 lds
    s_waitcnt lgkmcnt(6)
    v_mfma_f32_32x32x16_bf16 v[32:47], a[112:115], a[96:99], v[32:47]
    ds_read_b128 a[100:103], v101 offset:0
    ds_read_b64_tr_b16 a[128:129], v109 offset:0
    ds_read_b64_tr_b16 a[130:131], v109 offset:256
    v_mfma_f32_16x16x32_bf16 a[144:147], a[160:163], a[112:115], a[144:147]
    s_waitcnt lgkmcnt(7)
    v_mfma_f32_32x32x16_bf16 v[48:63], a[116:119], a[96:99], v[48:63]
    ds_read_b64_tr_b16 a[132:133], v109 offset:32
    ds_read_b64_tr_b16 a[134:135], v109 offset:288
    v_mfma_f32_16x16x32_bf16 a[148:151], a[160:163], a[116:119], a[148:151]
    s_waitcnt lgkmcnt(7)
    v_mfma_f32_32x32x16_bf16 v[64:79], a[120:123], a[96:99], v[64:79]
    ds_read_b64_tr_b16 a[136:137], v109 offset:512
    ds_read_b64_tr_b16 a[138:139], v109 offset:768
    buffer_load_dwordx4 v15, s[20:23], s43 offen offset:2048 lds
    s_add_u32 s43, s43, 12288
    s_cmp_eq_u32 s59, 6
    s_cselect_b32 s48, 86016, 0
    s_sub_u32 s43, s43, s48
    s_add_u32 s59, s59, 1
    s_add_u32 m0, s41, 16512
    v_mfma_f32_16x16x32_bf16 a[152:155], a[160:163], a[120:123], a[152:155]
    s_waitcnt lgkmcnt(7)
    v_mfma_f32_32x32x16_bf16 v[80:95], a[124:127], a[96:99], v[80:95]
    ds_read_b64_tr_b16 a[140:141], v109 offset:544
    ds_read_b64_tr_b16 a[142:143], v109 offset:800
    buffer_load_dwordx4 v15, s[20:23], s43 offen offset:0 lds
    v_mfma_f32_16x16x32_bf16 a[156:159], a[160:163], a[124:127], a[156:159]
    s_waitcnt lgkmcnt(6)
    v_mfma_f32_32x32x16_bf16 v[32:47], a[128:131], a[100:103], v[32:47]
    ds_read_b128 a[104:107], v102 offset:0
    ds_read_b64_tr_b16 a[112:113], v110 offset:0
    ds_read_b64_tr_b16 a[114:115], v110 offset:256
    s_waitcnt lgkmcnt(7)
    v_mfma_f32_32x32x16_bf16 v[48:63], a[132:135], a[100:103], v[48:63]
    ds_read_b64_tr_b16 a[116:117], v110 offset:32
    ds_read_b64_tr_b16 a[118:119], v110 offset:288
    v_accvgpr_read_b32 v200, a144
    ds_write_b32 v225, v200 offset:0
    s_waitcnt lgkmcnt(8)
    v_mfma_f32_32x32x16_bf16 v[64:79], a[136:139], a[100:103], v[64:79]
    ds_read_b64_tr_b16 a[120:121], v110 offset:512
    ds_read_b64_tr_b16 a[122:123], v110 offset:768
    buffer_load_dwordx4 v15, s[20:23], s43 offen offset:1024 lds
    s_waitcnt lgkmcnt(8)
    v_mfma_f32_32x32x16_bf16 v[80:95], a[140:143], a[100:103], v[80:95]
    ds_read_b64_tr_b16 a[124:125], v110 offset:544
    ds_read_b64_tr_b16 a[126:127], v110 offset:800
    v_accvgpr_read_b32 v201, a148
    ds_write_b32 v225, v201 offset:512
    s_waitcnt lgkmcnt(8)
    v_mfma_f32_32x32x16_bf16 v[32:47], a[112:115], a[104:107], v[32:47]
    ds_read_b128 a[108:111], v103 offset:0
    ds_read_b64_tr_b16 a[128:129], v111 offset:0
    ds_read_b64_tr_b16 a[130:131], v111 offset:256
    v_cmp_gt_u32 s[54:55], 32, v1
    s_waitcnt lgkmcnt(9)
    v_mfma_f32_32x32x16_bf16 v[48:63], a[116:119], a[104:107], v[48:63]
    ds_read_b64_tr_b16 a[132:133], v111 offset:32
    ds_read_b64_tr_b16 a[134:135], v111 offset:288
    v_accvgpr_read_b32 v202, a152
    ds_write_b32 v225, v202 offset:1024
    s_waitcnt lgkmcnt(9)
    v_mfma_f32_32x32x16_bf16 v[64:79], a[120:123], a[104:107], v[64:79]
    ds_read_b64_tr_b16 a[136:137], v111 offset:512
    ds_read_b64_tr_b16 a[138:139], v111 offset:768
    buffer_load_dwordx4 v15, s[20:23], s43 offen offset:2048 lds
    s_add_u32 s43, s43, 12288
    s_cmp_eq_u32 s59, 6
    s_cselect_b32 s48, 86016, 0
    s_sub_u32 s43, s43, s48
    s_add_u32 s59, s59, 1
    s_add_u32 m0, s41, 33024
    s_waitcnt lgkmcnt(9)
    v_mfma_f32_32x32x16_bf16 v[80:95], a[124:127], a[104:107], v[80:95]
    ds_read_b64_tr_b16 a[140:141], v111 offset:544
    ds_read_b64_tr_b16 a[142:143], v111 offset:800
    v_accvgpr_read_b32 v203, a156
    ds_write_b32 v225, v203 offset:1536
    s_waitcnt vmcnt(6) lgkmcnt(0)
    s_barrier
    v_mfma_f32_32x32x16_bf16 v[32:47], a[128:131], a[108:111], v[32:47]
    ds_read_b128 a[112:115], v196 offset:33024
    ds_read_b128 a[116:119], v196 offset:34048
    ds_read_b128 a[120:123], v196 offset:35072
    ds_read_b128 a[124:127], v197 offset:33024
    ds_read_b128 v[216:219], v226 offset:0
    ds_read_b128 v[220:223], v226 offset:512
    v_mfma_f32_32x32x16_bf16 v[48:63], a[132:135], a[108:111], v[48:63]
    ds_read_b128 a[128:131], v197 offset:34048
    v_cmp_ne_u32 vcc, s75, v24
    s_nop 0
    s_cbranch_vccnz L_slowS_3
L_okS_4:
    s_waitcnt lgkmcnt(2)
    v_add_f32 v216, v216, v217
    v_mfma_f32_32x32x16_bf16 v[64:79], a[136:139], a[108:111], v[64:79]
    ds_read_b128 a[132:135], v197 offset:35072
    v_cndmask_b32 v204, 0, v22, s[54:55]
    v_add_f32 v218, v218, v219
    v_add_f32 v216, v216, v218
    v_mfma_f32_32x32x16_bf16 v[80:95], a[140:143], a[108:111], v[80:95]
    v_mul_f32 v224, v23, v23
    v_cvt_pk_bf16_f32 v217, v216, v216
    v_and_b32 v217, s47, v217
    v_sub_f32 v216, v216, v217
    v_mfma_f32_32x32x16_bf16 v[144:159], a[0:3], a[112:115], 0
    ds_read_b128 a[136:139], v198 offset:33024
    buffer_load_dwordx4 v15, s[20:23], s43 offen offset:0 lds
    v_and_b32 v2, 31, v1
    v_lshlrev_b32 v2, 2, v2
    s_lshl_b32 s48, s38, 7
    s_add_u32 s48, s48, 132096
    v_add_u32 v2, s48, v2
    ds_write_b32 v2, v23
    v_mfma_f32_16x16x32_bf16 a[144:147], a[160:163], a[112:115], 0
    v_cvt_pk_bf16_f32 v208, v217, v216
    s_nop 1
    v_mfma_f32_32x32x16_bf16 v[32:47], v[208:211], v[204:207], v[32:47]
    ds_read_b128 v[216:219], v226 offset:1024
    v_mfma_f32_32x32x16_bf16 v[160:175], a[0:3], a[116:119], 0
    ds_read_b128 a[140:143], v198 offset:34048
    v_mfma_f32_16x16x32_bf16 a[148:151], a[160:163], a[116:119], 0
    s_waitcnt lgkmcnt(6)
    v_add_f32 v220, v220, v221
    v_mfma_f32_32x32x16_bf16 v[176:191], a[120:123], a[0:3], 0
    ds_read_b128 a[112:115], v198 offset:35072
    buffer_load_dwordx4 v15, s[20:23], s43 offen offset:1024 lds
    s_nop 2
    v_max_f32 v32, 0, v32
    v_mul_f32 v40, v224, v40
    v_mfma_f32_16x16x32_bf16 a[152:155], a[160:163], a[120:123], 0
    v_max_f32 v33, 0, v33
    v_mfma_f32_32x32x16_bf16 v[144:159], a[4:7], a[124:127], v[144:159]
    ds_read_b128 a[116:119], v199 offset:33024
    v_add_f32 v222, v222, v223
    v_mul_f32 v41, v224, v41
    v_mul_f32 v32, v32, v40
    s_waitcnt lgkmcnt(7)
    v_mfma_f32_32x32x16_bf16 v[160:175], a[4:7], a[128:131], v[160:175]
    ds_read_b128 a[120:123], v199 offset:34048
    v_mul_f32 v33, v33, v41
    v_cvt_pk_bf16_f32 v32, v32, v33
    s_waitcnt lgkmcnt(7)
    v_mfma_f32_32x32x16_bf16 v[176:191], a[132:135], a[4:7], v[176:191]
    ds_read_b128 a[124:127], v199 offset:35072
    buffer_load_dwordx4 v15, s[20:23], s43 offen offset:2048 lds
    s_add_u32 s43, s43, 12288
    s_cmp_eq_u32 s59, 6
    s_cselect_b32 s48, 86016, 0
    s_sub_u32 s43, s43, s48
    s_add_u32 s59, s59, 1
    s_add_u32 m0, s41, 49536
    s_waitcnt lgkmcnt(7)
    v_mfma_f32_32x32x16_bf16 v[144:159], a[8:11], a[136:139], v[144:159]
    ds_read_b128 a[128:131], v196 offset:49536
    v_add_f32 v220, v220, v222
    v_max_f32 v34, 0, v34
    v_mul_f32 v42, v224, v42
    s_waitcnt lgkmcnt(5)
    v_mfma_f32_32x32x16_bf16 v[160:175], a[8:11], a[140:143], v[160:175]
    ds_read_b128 a[132:135], v196 offset:50560
    v_max_f32 v35, 0, v35
    v_mul_f32 v43, v224, v43
    s_waitcnt lgkmcnt(5)
    v_mfma_f32_32x32x16_bf16 v[176:191], a[112:115], a[8:11], v[176:191]
    ds_read_b128 a[136:139], v196 offset:51584
    v_subrev_u32 v196, 66048, v196
    v_cvt_pk_bf16_f32 v221, v220, v220
    v_mul_f32 v34, v34, v42
    v_mul_f32 v35, v35, v43
    s_waitcnt lgkmcnt(5)
    v_mfma_f32_32x32x16_bf16 v[144:159], a[12:15], a[116:119], v[144:159]
    ds_read_b128 a[140:143], v197 offset:49536
    v_cvt_pk_bf16_f32 v33, v34, v35
    v_max_f32 v36, 0, v36
    s_waitcnt lgkmcnt(5)
    v_mfma_f32_32x32x16_bf16 v[160:175], a[12:15], a[120:123], v[160:175]
    ds_read_b128 a[112:115], v197 offset:50560
    v_mul_f32 v44, v224, v44
    v_max_f32 v37, 0, v37
    s_waitcnt lgkmcnt(5)
    v_mfma_f32_32x32x16_bf16 v[176:191], a[124:127], a[12:15], v[176:191]
    ds_read_b128 a[116:119], v197 offset:51584
    v_subrev_u32 v197, 66048, v197
    v_and_b32 v221, s47, v221
    v_mul_f32 v45, v224, v45
    v_mul_f32 v36, v36, v44
    s_waitcnt lgkmcnt(5)
    v_mfma_f32_32x32x16_bf16 v[144:159], a[16:19], a[128:131], v[144:159]
    ds_read_b128 a[120:123], v198 offset:49536
    buffer_load_dwordx4 v15, s[20:23], s43 offen offset:0 lds
    v_mul_f32 v37, v37, v45
    v_mfma_f32_16x16x32_bf16 a[144:147], a[160:163], a[128:131], a[144:147]
    v_cvt_pk_bf16_f32 v34, v36, v37
    s_waitcnt lgkmcnt(5)
    v_mfma_f32_32x32x16_bf16 v[160:175], a[16:19], a[132:135], v[160:175]
    ds_read_b128 a[124:127], v198 offset:50560
    v_sub_f32 v220, v220, v221
    v_max_f32 v38, 0, v38
    v_mul_f32 v46, v224, v46
    v_mfma_f32_16x16x32_bf16 a[148:151], a[160:163], a[132:135], a[148:151]
    v_max_f32 v39, 0, v39
    s_waitcnt lgkmcnt(5)
    v_mfma_f32_32x32x16_bf16 v[176:191], a[136:139], a[16:19], v[176:191]
    ds_read_b128 a[128:131], v198 offset:51584
    v_subrev_u32 v198, 66048, v198
    buffer_load_dwordx4 v15, s[20:23], s43 offen offset:1024 lds
    v_mul_f32 v47, v224, v47
    v_mfma_f32_16x16x32_bf16 a[152:155], a[160:163], a[136:139], a[152:155]
    v_cvt_pk_bf16_f32 v212, v221, v220
    v_mul_f32 v38, v38, v46
    s_waitcnt lgkmcnt(5)
    v_mfma_f32_32x32x16_bf16 v[144:159], a[20:23], a[140:143], v[144:159]
    ds_read_b128 a[132:135], v199 offset:49536
    v_mul_f32 v39, v39, v47
    v_cvt_pk_bf16_f32 v35, v38, v39
    v_mfma_f32_32x32x16_bf16 v[48:63], v[212:215], v[204:207], v[48:63]
    ds_read_b128 v[220:223], v226 offset:1536
    s_add_u32 s50, s73, 0
    buffer_store_dwordx4 v[32:35], v15, s[28:31], s50 offen sc1
    s_waitcnt lgkmcnt(6)
    v_mfma_f32_32x32x16_bf16 v[160:175], a[20:23], a[112:115], v[160:175]
    ds_read_b128 a[136:139], v199 offset:50560
    buffer_load_dwordx4 v15, s[20:23], s43 offen offset:2048 lds
    s_add_u32 s43, s43, 12288
    s_cmp_eq_u32 s59, 6
    s_cselect_b32 s48, 86016, 0
    s_sub_u32 s43, s43, s48
    s_add_u32 s59, s59, 1
    s_add_u32 m0, s41, 66048
    s_waitcnt lgkmcnt(6)
    v_mfma_f32_32x32x16_bf16 v[176:191], a[116:119], a[20:23], v[176:191]
    ds_read_b128 a[140:143], v199 offset:51584
    v_subrev_u32 v199, 66048, v199
    v_max_f32 v48, 0, v48
    v_mul_f32 v56, v224, v56
    s_waitcnt vmcnt(7) lgkmcnt(0)
    s_barrier
    v_mfma_f32_32x32x16_bf16 v[144:159], a[24:27], a[120:123], v[144:159]
    ds_read_b128 a[112:115], v196 offset:0
    v_add_f32 v216, v216, v217
    v_max_f32 v49, 0, v49
    v_mul_f32 v57, v224, v57
    v_mfma_f32_32x32x16_bf16 v[160:175], a[24:27], a[124:127], v[160:175]
    ds_read_b128 a[116:119], v196 offset:1024
    v_mul_f32 v48, v48, v56
    v_mul_f32 v49, v49, v57
    v_mfma_f32_32x32x16_bf16 v[176:191], a[128:131], a[24:27], v[176:191]
    ds_read_b128 a[120:123], v196 offset:2048
    v_add_f32 v218, v218, v219
    v_cvt_pk_bf16_f32 v48, v48, v49
    v_max_f32 v50, 0, v50
    v_mfma_f32_32x32x16_bf16 v[144:159], a[28:31], a[132:135], v[144:159]
    ds_read_b128 a[124:127], v197 offset:0
    v_mul_f32 v58, v224, v58
    v_max_f32 v51, 0, v51
    v_mfma_f32_32x32x16_bf16 v[160:175], a[28:31], a[136:139], v[160:175]
    ds_read_b128 a[128:131], v197 offset:1024
    v_add_f32 v216, v216, v218
    v_mul_f32 v59, v224, v59
    v_mul_f32 v50, v50, v58
    v_mfma_f32_32x32x16_bf16 v[176:191], a[140:143], a[28:31], v[176:191]
    ds_read_b128 a[132:135], v197 offset:2048
    v_cvt_pk_bf16_f32 v217, v216, v216
    v_mul_f32 v51, v51, v59
    v_cvt_pk_bf16_f32 v49, v50, v51
    s_waitcnt lgkmcnt(5)
    v_mfma_f32_32x32x16_bf16 v[144:159], a[32:35], a[112:115], v[144:159]
    ds_read_b128 a[136:139], v198 offset:0
    buffer_load_dwordx4 v15, s[20:23], s43 offen offset:0 lds
    v_max_f32 v52, 0, v52
    v_mfma_f32_16x16x32_bf16 a[144:147], a[160:163], a[112:115], a[144:147]
    v_mul_f32 v60, v224, v60
    buffer_load_dword v30, v30, s[60:63], 0 offen sc1
    s_waitcnt lgkmcnt(5)
    v_mfma_f32_32x32x16_bf16 v[160:175], a[32:35], a[116:119], v[160:175]
    ds_read_b128 a[140:143], v198 offset:1024
    v_and_b32 v217, s47, v217
    v_max_f32 v53, 0, v53
    v_mul_f32 v61, v224, v61
    v_mfma_f32_16x16x32_bf16 a[148:151], a[160:163], a[116:119], a[148:151]
    v_mul_f32 v52, v52, v60
    s_waitcnt lgkmcnt(5)
    v_mfma_f32_32x32x16_bf16 v[176:191], a[120:123], a[32:35], v[176:191]
    ds_read_b128 a[112:115], v198 offset:2048
    buffer_load_dwordx4 v15, s[20:23], s43 offen offset:1024 lds
    v_mul_f32 v53, v53, v61
    v_cvt_pk_bf16_f32 v50, v52, v53
    v_mfma_f32_16x16x32_bf16 a[152:155], a[160:163], a[120:123], a[152:155]
    v_max_f32 v54, 0, v54
    s_waitcnt lgkmcnt(5)
    v_mfma_f32_32x32x16_bf16 v[144:159], a[36:39], a[124:127], v[144:159]
    ds_read_b128 a[116:119], v199 offset:0
    v_sub_f32 v216, v216, v217
    v_mul_f32 v62, v224, v62
    v_max_f32 v55, 0, v55
    s_waitcnt lgkmcnt(5)
    v_mfma_f32_32x32x16_bf16 v[160:175], a[36:39], a[128:131], v[160:175]
    ds_read_b128 a[120:123], v199 offset:1024
    v_mul_f32 v63, v224, v63
    v_mul_f32 v54, v54, v62
    s_waitcnt lgkmcnt(5)
    v_mfma_f32_32x32x16_bf16 v[176:191], a[132:135], a[36:39], v[176:191]
    ds_read_b128 a[124:127], v199 offset:2048
    buffer_load_dwordx4 v15, s[20:23], s43 offen offset:2048 lds
    s_add_u32 s43, s43, 1388544
    s_cmp_eq_u32 s59, 6
    s_cselect_b32 s48, 86016, 0
    s_sub_u32 s43, s43, s48
    s_mov_b32 s59, s3
    s_add_u32 m0, s41, 82560
    s_waitcnt lgkmcnt(5)
    v_mfma_f32_32x32x16_bf16 v[144:159], a[40:43], a[136:139], v[144:159]
    ds_read_b128 a[128:131], v196 offset:16512
    v_cvt_pk_bf16_f32 v208, v217, v216
    v_mul_f32 v55, v55, v63
    v_cvt_pk_bf16_f32 v51, v54, v55
    v_mfma_f32_32x32x16_bf16 v[64:79], v[208:211], v[204:207], v[64:79]
    s_add_u32 s50, s73, 1024
    buffer_store_dwordx4 v[48:51], v15, s[28:31], s50 offen sc1
    s_waitcnt lgkmcnt(5)
    v_mfma_f32_32x32x16_bf16 v[160:175], a[40:43], a[140:143], v[160:175]
    ds_read_b128 a[132:135], v196 offset:17536
    s_waitcnt lgkmcnt(5)
    v_mfma_f32_32x32x16_bf16 v[176:191], a[112:115], a[40:43], v[176:191]
    ds_read_b128 a[136:139], v196 offset:18560
    v_add_f32 v220, v220, v221
    s_nop 2
    v_max_f32 v64, 0, v64
    v_mul_f32 v72, v224, v72
    s_waitcnt lgkmcnt(5)
    v_mfma_f32_32x32x16_bf16 v[144:159], a[44:47], a[116:119], v[144:159]
    ds_read_b128 a[140:143], v197 offset:16512
    v_max_f32 v65, 0, v65
    v_mul_f32 v73, v224, v73
    s_waitcnt lgkmcnt(5)
    v_mfma_f32_32x32x16_bf16 v[160:175], a[44:47], a[120:123], v[160:175]
    ds_read_b128 a[112:115], v197 offset:17536
    v_add_f32 v222, v222, v223
    v_mul_f32 v64, v64, v72
    s_waitcnt lgkmcnt(5)
    v_mfma_f32_32x32x16_bf16 v[176:191], a[124:127], a[44:47], v[176:191]
    ds_read_b128 a[116:119], v197 offset:18560
    v_mul_f32 v65, v65, v73
    v_cvt_pk_bf16_f32 v64, v64, v65
    s_waitcnt lgkmcnt(5)
    v_mfma_f32_32x32x16_bf16 v[144:159], a[48:51], a[128:131], v[144:159]
    ds_read_b128 a[120:123], v198 offset:16512
    v_add_f32 v220, v220, v222
    v_max_f32 v66, 0, v66
    v_mul_f32 v74, v224, v74
    v_mfma_f32_16x16x32_bf16 a[144:147], a[160:163], a[128:131], a[144:147]
    v_max_f32 v67, 0, v67
    s_waitcnt lgkmcnt(5)
    v_mfma_f32_32x32x16_bf16 v[160:175], a[48:51], a[132:135], v[160:175]
    ds_read_b128 a[124:127], v198 offset:17536
    v_mul_f32 v75, v224, v75
    v_mul_f32 v66, v66, v74
    v_mfma_f32_16x16x32_bf16 a[148:151], a[160:163], a[132:135], a[148:151]
    v_mul_f32 v67, v67, v75
    s_waitcnt lgkmcnt(5)
    v_mfma_f32_32x32x16_bf16 v[176:191], a[136:139], a[48:51], v[176:191]
    ds_read_b128 a[128:131], v198 offset:18560
    v_cvt_pk_bf16_f32 v221, v220, v220
    v_cvt_pk_bf16_f32 v65, v66, v67
    v_mfma_f32_16x16x32_bf16 a[152:155], a[160:163], a[136:139], a[152:155]
    v_max_f32 v68, 0, v68
    s_waitcnt lgkmcnt(5)
    v_mfma_f32_32x32x16_bf16 v[144:159], a[52:55], a[140:143], v[144:159]
    ds_read_b128 a[132:135], v199 offset:16512
    v_mul_f32 v76, v224, v76
    v_max_f32 v69, 0, v69
    s_waitcnt lgkmcnt(5)
    v_mfma_f32_32x32x16_bf16 v[160:175], a[52:55], a[112:115], v[160:175]
    ds_read_b128 a[136:139], v199 offset:17536
    v_and_b32 v221, s47, v221
    v_mul_f32 v77, v224, v77
    v_mul_f32 v68, v68, v76
    s_waitcnt lgkmcnt(5)
    v_mfma_f32_32x32x16_bf16 v[176:191], a[116:119], a[52:55], v[176:191]
    ds_read_b128 a[140:143], v199 offset:18560
    v_mul_f32 v69, v69, v77
    v_cvt_pk_bf16_f32 v66, v68, v69
    s_waitcnt vmcnt(5) lgkmcnt(0)
    s_barrier
    v_mfma_f32_32x32x16_bf16 v[144:159], a[56:59], a[120:123], v[144:159]
    ds_read_b128 a[112:115], v196 offset:33024
    v_sub_f32 v220, v220, v221
    v_max_f32 v70, 0, v70
    v_mfma_f32_32x32x16_bf16 v[160:175], a[56:59], a[124:127], v[160:175]
    ds_read_b128 a[116:119], v196 offset:34048
    v_mul_f32 v78, v224, v78
    v_max_f32 v71, 0, v71
    buffer_load_dword v227, v227, s[60:63], 0 offen sc1
    v_mfma_f32_32x32x16_bf16 v[176:191], a[128:131], a[56:59], v[176:191]
    ds_read_b128 a[120:123], v196 offset:35072
    v_cvt_pk_bf16_f32 v212, v221, v220
    v_mul_f32 v79, v224, v79
    v_mul_f32 v70, v70, v78
    v_mfma_f32_32x32x16_bf16 v[144:159], a[60:63], a[132:135], v[144:159]
    ds_read_b128 a[124:127], v197 offset:33024
    v_mul_f32 v71, v71, v79
    v_cvt_pk_bf16_f32 v67, v70, v71
    v_mfma_f32_32x32x16_bf16 v[80:95], v[212:215], v[204:207], v[80:95]
    s_add_u32 s50, s73, 2048
    buffer_store_dwordx4 v[64:67], v15, s[28:31], s50 offen sc1
    v_mfma_f32_32x32x16_bf16 v[160:175], a[60:63], a[136:139], v[160:175]
    ds_read_b128 a[128:131], v197 offset:34048
    v_mfma_f32_32x32x16_bf16 v[176:191], a[140:143], a[60:63], v[176:191]
    ds_read_b128 a[132:135], v197 offset:35072
    s_nop 5
    v_max_f32 v80, 0, v80
    v_mul_f32 v88, v224, v88
    v_max_f32 v81, 0, v81
    s_waitcnt vmcnt(5)
    v_cmp_ne_u32 vcc, s75, v30
    s_nop 0
    s_cbranch_vccnz L_slowB_5
L_okB_6:
    s_waitcnt lgkmcnt(5)
    v_mfma_f32_32x32x16_bf16 v[144:159], a[64:67], a[112:115], v[144:159]
    ds_read_b128 a[136:139], v198 offset:33024
    buffer_load_dwordx4 v15, s[20:23], s43 offen offset:0 lds
    v_mul_f32 v89, v224, v89
    v_mul_f32 v80, v80, v88
    v_mfma_f32_16x16x32_bf16 a[144:147], a[160:163], a[112:115], a[144:147]
    v_mul_f32 v81, v81, v89
    s_waitcnt lgkmcnt(5)
    v_mfma_f32_32x32x16_bf16 v[160:175], a[64:67], a[116:119], v[160:175]
    ds_read_b128 a[140:143], v198 offset:34048
    v_cvt_pk_bf16_f32 v80, v80, v81
    v_max_f32 v82, 0, v82
    v_mfma_f32_16x16x32_bf16 a[148:151], a[160:163], a[116:119], a[148:151]
    v_mul_f32 v90, v224, v90
    s_waitcnt lgkmcnt(5)
    v_mfma_f32_32x32x16_bf16 v[176:191], a[120:123], a[64:67], v[176:191]
    ds_read_b128 a[112:115], v198 offset:35072
    buffer_load_dwordx4 v15, s[20:23], s43 offen offset:1024 lds
    v_max_f32 v83, 0, v83
    v_mul_f32 v91, v224, v91
    v_mfma_f32_16x16x32_bf16 a[152:155], a[160:163], a[120:123], a[152:155]
    v_mul_f32 v82, v82, v90
    s_waitcnt lgkmcnt(5)
    v_mfma_f32_32x32x16_bf16 v[144:159], a[68:71], a[124:127], v[144:159]
    ds_read_b128 a[116:119], v199 offset:33024
    v_mul_f32 v83, v83, v91
    v_cvt_pk_bf16_f32 v81, v82, v83
    v_max_f32 v84, 0, v84
    s_waitcnt lgkmcnt(5)
    v_mfma_f32_32x32x16_bf16 v[160:175], a[68:71], a[128:131], v[160:175]
    ds_read_b128 a[120:123], v199 offset:34048
    v_mul_f32 v92, v224, v92
    v_max_f32 v85, 0, v85
    s_waitcnt lgkmcnt(5)
    v_mfma_f32_32x32x16_bf16 v[176:191], a[132:135], a[68:71], v[176:191]
    ds_read_b128 a[124:127], v199 offset:35072
    buffer_load_dwordx4 v15, s[20:23], s43 offen offset:2048 lds
    s_add_u32 s43, s43, 12288
    s_cmp_eq_u32 s59, 6
    s_cselect_b32 s48, 86016, 0
    s_sub_u32 s43, s43, s48
    s_add_u32 s59, s59, 1
    s_add_u32 m0, s41, 99072
    s_waitcnt lgkmcnt(5)
    v_mfma_f32_32x32x16_bf16 v[144:159], a[72:75], a[136:139], v[144:159]
    ds_read_b128 a[128:131], v196 offset:49536
    buffer_load_dwordx4 v15, s[20:23], s43 offen offset:0 lds
    v_mul_f32 v93, v224, v93
    v_mul_f32 v84, v84, v92
    s_waitcnt lgkmcnt(5)
    v_mfma_f32_32x32x16_bf16 v[160:175], a[72:75], a[140:143], v[160:175]
    ds_read_b128 a[132:135], v196 offset:50560
    v_mul_f32 v85, v85, v93
    v_cvt_pk_bf16_f32 v82, v84, v85
    v_max_f32 v86, 0, v86
    s_waitcnt lgkmcnt(5)
    v_mfma_f32_32x32x16_bf16 v[176:191], a[112:115], a[72:75], v[176:191]
    ds_read_b128 a[136:139], v196 offset:51584
    v_add_u32 v196, 66048, v196
    v_mul_f32 v94, v224, v94
    v_max_f32 v87, 0, v87
    s_waitcnt lgkmcnt(5)
    v_mfma_f32_32x32x16_bf16 v[144:159], a[76:79], a[116:119], v[144:159]
    ds_read_b128 a[140:143], v197 offset:49536
    v_mul_f32 v95, v224, v95
    v_mul_f32 v86, v86, v94
    s_waitcnt lgkmcnt(5)
    v_mfma_f32_32x32x16_bf16 v[160:175], a[76:79], a[120:123], v[160:175]
    ds_read_b128 a[112:115], v197 offset:50560
    buffer_load_dwordx4 v15, s[20:23], s43 offen offset:1024 lds
    v_mul_f32 v87, v87, v95
    v_cvt_pk_bf16_f32 v83, v86, v87
    s_waitcnt lgkmcnt(5)
    v_mfma_f32_32x32x16_bf16 v[176:191], a[124:127], a[76:79], v[176:191]
    ds_read_b128 a[116:119], v197 offset:51584
    v_add_u32 v197, 66048, v197
    s_add_u32 s50, s73, 3072
    buffer_store_dwordx4 v[80:83], v15, s[28:31], s50 offen sc1
    s_waitcnt lgkmcnt(5)
    v_mfma_f32_32x32x16_bf16 v[144:159], a[80:83], a[128:131], v[144:159]
    ds_read_b128 a[120:123], v198 offset:49536
    v_mfma_f32_16x16x32_bf16 a[144:147], a[160:163], a[128:131], a[144:147]
    s_waitcnt lgkmcnt(5)
    v_mfma_f32_32x32x16_bf16 v[160:175], a[80:83], a[132:135], v[160:175]
    ds_read_b128 a[124:127], v198 offset:50560
    buffer_load_dwordx4 v15, s[20:23], s43 offen offset:2048 lds
    s_add_u32 s43, s43, 12288
    s_cmp_eq_u32 s59, 6
    s_cselect_b32 s48, 86016, 0
    s_sub_u32 s43, s43, s48
    s_add_u32 s59, s59, 1
    s_add_u32 m0, s41, 115584
    v_mfma_f32_16x16x32_bf16 a[148:151], a[160:163], a[132:135], a[148:151]
    s_waitcnt vmcnt(8)
    v_cmp_ne_u32 vcc, s75, v227
    s_nop 0
    s_cbranch_vccnz L_slowW_7
L_okW_8:
    s_waitcnt lgkmcnt(5)
    v_mfma_f32_32x32x16_bf16 v[176:191], a[136:139], a[80:83], v[176:191]
    ds_read_b128 a[128:131], v198 offset:51584
    v_add_u32 v198, 66048, v198
    buffer_load_dwordx4 v15, s[20:23], s43 offen offset:0 lds
    v_mfma_f32_16x16x32_bf16 a[152:155], a[160:163], a[136:139], a[152:155]
    s_waitcnt lgkmcnt(5)
    v_mfma_f32_32x32x16_bf16 v[144:159], a[84:87], a[140:143], v[144:159]
    ds_read_b128 a[132:135], v199 offset:49536
    buffer_load_dwordx4 a[164:167], v21, s[76:79], s80 offen sc1
    s_waitcnt lgkmcnt(5)
    v_mfma_f32_32x32x16_bf16 v[160:175], a[84:87], a[112:115], v[160:175]
    ds_read_b128 a[136:139], v199 offset:50560
    s_waitcnt lgkmcnt(5)
    v_mfma_f32_32x32x16_bf16 v[176:191], a[116:119], a[84:87], v[176:191]
    ds_read_b128 a[140:143], v199 offset:51584
    v_add_u32 v199, 66048, v199
    buffer_load_dwordx4 v15, s[20:23], s43 offen offset:1024 lds
    buffer_load_dwordx4 a[168:171], v28, s[76:79], s80 offen sc1
    s_waitcnt lgkmcnt(0)
    s_barrier
    v_mfma_f32_32x32x16_bf16 v[144:159], a[88:91], a[120:123], v[144:159]
    ds_read_b128 a[112:115], v196 offset:0
    v_mfma_f32_32x32x16_bf16 v[160:175], a[88:91], a[124:127], v[160:175]
    ds_read_b128 a[116:119], v196 offset:1024
    s_add_u32 s80, s80, 2048
    s_cmp_eq_u32 s80, s70
    s_cselect_b32 s80, s81, s80
    buffer_load_dwordx4 a[172:175], v21, s[76:79], s80 offen sc1
    v_mfma_f32_32x32x16_bf16 v[176:191], a[128:131], a[88:91], v[176:191]
    ds_read_b128 a[120:123], v196 offset:2048
    v_mfma_f32_32x32x16_bf16 v[144:159], a[92:95], a[132:135], v[144:159]
    ds_read_b128 a[124:127], v197 offset:0
    buffer_load_dwordx4 v15, s[20:23], s43 offen offset:2048 lds
    s_add_u32 s43, s43, 12288
    s_cmp_eq_u32 s59, 6
    s_cselect_b32 s48, 86016, 0
    s_sub_u32 s43, s43, s48
    s_add_u32 s59, s59, 1
    s_add_u32 m0, s41, 0
    buffer_load_dwordx4 a[176:179], v28, s[76:79], s80 offen sc1
    v_mfma_f32_32x32x16_bf16 v[160:175], a[92:95], a[136:139], v[160:175]
    ds_read_b128 a[128:131], v197 offset:1024
    v_mfma_f32_32x32x16_bf16 v[176:191], a[140:143], a[92:95], v[176:191]
    ds_read_b128 a[132:135], v197 offset:2048
    v_lshrrev_b32 v2, 5, v1
    v_lshlrev_b32 v2, 4, v2
    s_lshl_b32 s48, s38, 7
    s_add_u32 s48, s48, 132096
    v_add_u32 v2, s48, v2
    ds_read_b128 v[32:35], v2 offset:0
    ds_read_b128 v[36:39], v2 offset:32
    ds_read_b128 v[40:43], v2 offset:64
    ds_read_b128 v[44:47], v2 offset:96
    s_waitcnt lgkmcnt(9)
    v_mfma_f32_32x32x16_bf16 v[144:159], a[96:99], a[112:115], v[144:159]
    ds_read_b128 a[136:139], v198 offset:0
    buffer_load_dwordx4 v15, s[20:23], s43 offen offset:0 lds
    s_add_u32 s80, s80, 2048
    s_cmp_eq_u32 s80, s70
    s_cselect_b32 s80, s81, s80
    buffer_load_dwordx4 a[180:183], v21, s[76:79], s80 offen sc1
    v_mfma_f32_16x16x32_bf16 a[144:147], a[160:163], a[112:115], a[144:147]
    s_waitcnt lgkmcnt(9)
    v_mfma_f32_32x32x16_bf16 v[160:175], a[96:99], a[116:119], v[160:175]
    ds_read_b128 a[140:143], v198 offset:1024
    v_mfma_f32_16x16x32_bf16 a[148:151], a[160:163], a[116:119], a[148:151]
    s_waitcnt lgkmcnt(9)
    v_mfma_f32_32x32x16_bf16 v[176:191], a[120:123], a[96:99], v[176:191]
    ds_read_b128 a[112:115], v198 offset:2048
    buffer_load_dwordx4 v15, s[20:23], s43 offen offset:1024 lds
    v_mov_b32 v228, 0x358637bd
    buffer_load_dwordx4 a[184:187], v28, s[76:79], s80 offen sc1
    v_mfma_f32_16x16x32_bf16 a[152:155], a[160:163], a[120:123], a[152:155]
    v_mov_b32 v229, 0x3fb8aa3b
    s_waitcnt lgkmcnt(9)
    v_mfma_f32_32x32x16_bf16 v[144:159], a[100:103], a[124:127], v[144:159]
    ds_read_b128 a[116:119], v199 offset:0
    v_mov_b32 v230, 0xb5c1a2a0
    s_waitcnt lgkmcnt(9)
    v_mfma_f32_32x32x16_bf16 v[160:175], a[100:103], a[128:131], v[160:175]
    ds_read_b128 a[120:123], v199 offset:1024
    v_accvgpr_read_b32 v200, a144
    ds_write_b32 v225, v200 offset:4096
    v_accvgpr_read_b32 v201, a148
    ds_write_b32 v225, v201 offset:4608
    s_add_u32 s80, s80, 2048
    s_cmp_eq_u32 s80, s70
    s_cselect_b32 s80, s81, s80
    buffer_load_dwordx4 a[188:191], v21, s[76:79], s80 offen sc1
    s_waitcnt lgkmcnt(11)
    v_mfma_f32_32x32x16_bf16 v[176:191], a[132:135], a[100:103], v[176:191]
    ds_read_b128 a[124:127], v199 offset:2048
    v_accvgpr_read_b32 v202, a152
    ds_write_b32 v225, v202 offset:3584
    buffer_load_dwordx4 v15, s[20:23], s43 offen offset:2048 lds
    s_add_u32 s43, s43, 12288
    s_cmp_eq_u32 s59, 6
    s_cselect_b32 s48, 86016, 0
    s_sub_u32 s43, s43, s48
    s_add_u32 s59, s59, 1
    s_add_u32 m0, s41, 16512
    s_waitcnt vmcnt(17) lgkmcnt(0)
    s_barrier
    v_mfma_f32_32x32x16_bf16 v[144:159], a[104:107], a[136:139], v[144:159]
    ds_read_b128 a[128:131], v196 offset:16512
    v_mov_b32 v231, 0x3f803f80
    ds_read_b128 v[216:219], v226 offset:4096
    ds_read_b128 v[220:223], v226 offset:4608
    v_mfma_f32_32x32x16_bf16 v[160:175], a[104:107], a[140:143], v[160:175]
    ds_read_b128 a[132:135], v196 offset:17536
    v_and_b32 v3, 31, v1
    v_cmp_eq_u32 s[52:53], 28, v3
    s_waitcnt lgkmcnt(2)
    v_add_f32 v216, v216, v217
    v_add_f32 v218, v218, v219
    v_add_f32 v216, v216, v218
    v_cvt_pk_bf16_f32 v217, v216, v216
    v_and_b32 v217, s47, v217
    v_sub_f32 v216, v216, v217
    buffer_load_dwordx4 a[192:195], v28, s[76:79], s80 offen sc1
    v_mfma_f32_32x32x16_bf16 v[176:191], a[112:115], a[104:107], v[176:191]
    ds_read_b128 a[136:139], v196 offset:18560
    s_waitcnt vmcnt(15)
    s_lshl_b32 s50, s36, 8
    s_lshr_b32 s51, s38, 1
    s_lshl_b32 s51, s51, 7
    s_add_u32 s50, s50, s51
    s_lshl_b32 s51, s37, 3
    s_add_u32 s50, s50, s51
    s_and_b32 s51, s38, 1
    s_lshl_b32 s51, s51, 2
    s_add_u32 s50, s50, s51
    v_mov_b32 v2, s50
    v_mov_b32 v3, s75
    s_mov_b64 exec, 1
    buffer_store_dword v3, v2, s[60:63], 0 offen sc1
    s_mov_b64 exec, -1
    v_mfma_f32_32x32x16_bf16 v[144:159], a[108:111], a[116:119], v[144:159]
    ds_read_b128 a[140:143], v197 offset:16512
    v_cvt_pk_bf16_f32 v208, v217, v216
    s_nop 1
    v_mfma_f32_32x32x16_bf16 v[144:159], v[204:207], v[208:211], v[144:159]
    ds_read_b128 v[216:219], v226 offset:3584
    s_waitcnt lgkmcnt(4)
    v_add_f32 v220, v220, v221
    v_add_f32 v222, v222, v223
    v_add_f32 v220, v220, v222
    v_cvt_pk_bf16_f32 v221, v220, v220
    v_and_b32 v221, s47, v221
    v_sub_f32 v220, v220, v221
    s_add_u32 s80, s80, 2048
    s_cmp_eq_u32 s80, s70
    s_cselect_b32 s80, s81, s80
    buffer_load_dwordx4 a[196:199], v21, s[76:79], s80 offen sc1
    v_mfma_f32_32x32x16_bf16 v[160:175], a[108:111], a[120:123], v[160:175]
    ds_read_b128 a[112:115], v197 offset:17536
    v_cvt_pk_bf16_f32 v212, v221, v220
    s_nop 1
    v_mfma_f32_32x32x16_bf16 v[160:175], v[204:207], v[212:215], v[160:175]
    v_fma_f32 v234, v144, v32, v228
    v_fma_f32 v235, v145, v33, v228
    v_fma_f32 v232, v234, v229, v230
    v_fma_f32 v233, v235, v229, v230
    v_exp_f32 v232, v232 clamp
    v_exp_f32 v233, v233 clamp
    v_max_f32 v234, v228, v234
    v_max_f32 v235, v228, v235
    v_mfma_f32_32x32x16_bf16 v[176:191], a[124:127], a[108:111], v[176:191]
    ds_read_b128 a[116:119], v197 offset:18560
    v_add_f32 v232, v232, v234
    v_add_f32 v233, v233, v235
    v_cvt_pk_bf16_f32 v240, v232, v233
    v_fma_f32 v238, v146, v34, v228
    v_fma_f32 v239, v147, v35, v228
    v_fma_f32 v236, v238, v229, v230
    v_fma_f32 v237, v239, v229, v230
    v_exp_f32 v236, v236 clamp
    v_exp_f32 v237, v237 clamp
    v_max_f32 v238, v228, v238
    buffer_load_dwordx4 a[200:203], v28, s[76:79], s80 offen sc1
    v_mfma_f32_32x32x16_bf16 v[96:111], a[128:131], a[0:3], 0
    ds_read_b128 a[120:123], v198 offset:16512
    buffer_load_dwordx4 v15, s[20:23], s43 offen offset:0 lds
    v_max_f32 v239, v228, v239
    v_add_f32 v236, v236, v238
    v_add_f32 v237, v237, v239
    v_cvt_pk_bf16_f32 v241, v236, v237
    v_fma_f32 v234, v148, v36, v228
    v_fma_f32 v235, v149, v37, v228
    v_fma_f32 v232, v234, v229, v230
    v_mfma_f32_16x16x32_bf16 a[144:147], a[160:163], a[128:131], 0
    v_fma_f32 v233, v235, v229, v230
    v_exp_f32 v232, v232 clamp
    v_exp_f32 v233, v233 clamp
    v_max_f32 v234, v228, v234
    s_waitcnt lgkmcnt(6)
    v_mfma_f32_32x32x16_bf16 v[112:127], a[132:135], a[0:3], 0
    ds_read_b128 a[124:127], v198 offset:17536
    v_max_f32 v235, v228, v235
    v_add_f32 v232, v232, v234
    v_add_f32 v233, v233, v235
    v_cvt_pk_bf16_f32 v242, v232, v233
    v_fma_f32 v238, v150, v38, v228
    v_fma_f32 v239, v151, v39, v228
    v_fma_f32 v236, v238, v229, v230
    v_fma_f32 v237, v239, v229, v230
    v_exp_f32 v236, v236 clamp
    v_exp_f32 v237, v237 clamp
    v_mfma_f32_16x16x32_bf16 a[148:151], a[160:163], a[132:135], 0
    v_max_f32 v238, v228, v238
    v_max_f32 v239, v228, v239
    v_add_f32 v236, v236, v238
    v_add_f32 v237, v237, v239
    s_waitcnt lgkmcnt(6)
    v_mfma_f32_32x32x16_bf16 v[128:143], a[136:139], a[0:3], 0
    ds_read_b128 a[128:131], v198 offset:18560
    buffer_load_dwordx4 v15, s[20:23], s43 offen offset:1024 lds
    v_cvt_pk_bf16_f32 v243, v236, v237
    v_fma_f32 v234, v152, v40, v228
    v_fma_f32 v235, v153, v41, v228
    v_fma_f32 v232, v234, v229, v230
    v_fma_f32 v233, v235, v229, v230
    v_exp_f32 v232, v232 clamp
    v_exp_f32 v233, v233 clamp
    v_max_f32 v234, v228, v234
    s_add_u32 s80, s80, 2048
    s_cmp_eq_u32 s80, s70
    s_cselect_b32 s80, s81, s80
    buffer_load_dwordx4 a[204:207], v21, s[76:79], s80 offen sc1
    v_mfma_f32_16x16x32_bf16 a[152:155], a[160:163], a[136:139], 0
    v_max_f32 v235, v228, v235
    v_add_f32 v232, v232, v234
    v_add_f32 v233, v233, v235
    s_waitcnt lgkmcnt(6)
    v_mfma_f32_32x32x16_bf16 v[96:111], a[140:143], a[4:7], v[96:111]
    ds_read_b128 a[132:135], v199 offset:16512
    v_cvt_pk_bf16_f32 v244, v232, v233
    v_fma_f32 v238, v154, v42, v228
    v_fma_f32 v239, v155, v43, v228
    v_fma_f32 v236, v238, v229, v230
    v_fma_f32 v237, v239, v229, v230
    v_exp_f32 v236, v236 clamp
    v_exp_f32 v237, v237 clamp
    v_max_f32 v238, v228, v238
    v_max_f32 v239, v228, v239
    v_add_f32 v236, v236, v238
    s_waitcnt lgkmcnt(5)
    v_mfma_f32_32x32x16_bf16 v[112:127], a[112:115], a[4:7], v[112:127]
    ds_read_b128 a[136:139], v199 offset:17536
    v_add_f32 v237, v237, v239
    v_cvt_pk_bf16_f32 v245, v236, v237
    v_fma_f32 v234, v156, v44, v228
    v_fma_f32 v235, v157, v45, v228
    v_fma_f32 v232, v234, v229, v230
    v_fma_f32 v233, v235, v229, v230
    v_exp_f32 v232, v232 clamp
    v_exp_f32 v233, v233 clamp
    v_max_f32 v234, v228, v234
    v_max_f32 v235, v228, v235
    buffer_load_dwordx4 a[208:211], v28, s[76:79], s80 offen sc1
    s_waitcnt lgkmcnt(5)
    v_mfma_f32_32x32x16_bf16 v[128:143], a[116:119], a[4:7], v[128:143]
    ds_read_b128 a[140:143], v199 offset:18560
    buffer_load_dwordx4 v15, s[20:23], s43 offen offset:2048 lds
    s_add_u32 s43, s43, 12288
    s_cmp_eq_u32 s59, 6
    s_cselect_b32 s48, 86016, 0
    s_sub_u32 s43, s43, s48
    s_add_u32 s59, s59, 1
    s_add_u32 m0, s41, 33024
    s_waitcnt vmcnt(16) lgkmcnt(0)
    s_barrier
    v_mfma_f32_32x32x16_bf16 v[96:111], a[120:123], a[8:11], v[96:111]
    ds_read_b128 a[112:115], v196 offset:33024
    v_add_f32 v232, v232, v234
    v_add_f32 v233, v233, v235
    v_cvt_pk_bf16_f32 v246, v232, v233
    v_fma_f32 v238, v158, v46, v228
    v_fma_f32 v239, v159, v47, v228
    v_fma_f32 v236, v238, v229, v230
    v_fma_f32 v237, v239, v229, v230
    v_exp_f32 v236, v236 clamp
    v_exp_f32 v237, v237 clamp
    s_add_u32 s80, s80, 2048
    s_cmp_eq_u32 s80, s70
    s_cselect_b32 s80, s81, s80
    buffer_load_dwordx4 a[212:215], v21, s[76:79], s80 offen sc1
    v_mfma_f32_32x32x16_bf16 v[112:127], a[124:127], a[8:11], v[112:127]
    ds_read_b128 a[116:119], v196 offset:34048
    v_max_f32 v238, v228, v238
    v_max_f32 v239, v228, v239
    v_add_f32 v236, v236, v238
    v_add_f32 v237, v237, v239
    v_cvt_pk_bf16_f32 v247, v236, v237
    v_mul_f32 v160, v160, v32
    v_mul_f32 v161, v161, v33
    v_cvt_pk_bf16_f32 v160, v160, v161
    v_cndmask_b32 v160, v160, v231, s[52:53]
    v_mul_f32 v162, v162, v34
    v_mfma_f32_32x32x16_bf16 v[128:143], a[128:131], a[8:11], v[128:143]
    ds_read_b128 a[120:123], v196 offset:35072
    v_mul_f32 v163, v163, v35
    v_cvt_pk_bf16_f32 v161, v162, v163
    v_cndmask_b32 v161, v161, v231, s[52:53]
    v_mul_f32 v164, v164, v36
    v_mul_f32 v165, v165, v37
    v_cvt_pk_bf16_f32 v162, v164, v165
    v_cndmask_b32 v162, v162, v231, s[52:53]
    v_mul_f32 v166, v166, v38
    v_mul_f32 v167, v167, v39
    v_cvt_pk_bf16_f32 v163, v166, v167
    v_mfma_f32_32x32x16_bf16 v[96:111], a[132:135], a[12:15], v[96:111]
    ds_read_b128 a[124:127], v197 offset:33024
    v_cndmask_b32 v163, v163, v231, s[52:53]
    v_mul_f32 v168, v168, v40
    v_mul_f32 v169, v169, v41
    v_cvt_pk_bf16_f32 v164, v168, v169
    v_cndmask_b32 v164, v164, v231, s[52:53]
    v_mul_f32 v170, v170, v42
    v_mul_f32 v171, v171, v43
    v_cvt_pk_bf16_f32 v165, v170, v171
    v_cndmask_b32 v165, v165, v231, s[52:53]
    buffer_load_dwordx4 a[216:219], v28, s[76:79], s80 offen sc1
    v_mfma_f32_32x32x16_bf16 v[112:127], a[136:139], a[12:15], v[112:127]
    ds_read_b128 a[128:131], v197 offset:34048
    v_mul_f32 v172, v172, v44
    v_mul_f32 v173, v173, v45
    v_cvt_pk_bf16_f32 v166, v172, v173
    v_cndmask_b32 v166, v166, v231, s[52:53]
    v_mul_f32 v174, v174, v46
    v_mul_f32 v175, v175, v47
    v_cvt_pk_bf16_f32 v167, v174, v175
    v_cndmask_b32 v167, v167, v231, s[52:53]
    v_mfma_f32_32x32x16_bf16 v[144:159], v[240:243], v[160:163], 0
    s_nop 0
    v_mfma_f32_32x32x16_bf16 v[144:159], v[244:247], v[164:167], v[144:159]
    v_mfma_f32_32x32x16_bf16 v[128:143], a[140:143], a[12:15], v[128:143]
    ds_read_b128 a[132:135], v197 offset:35072
    s_lshl_b32 s48, s38, 12
    s_add_u32 s48, s48, 145920
    v_add_u32 v2, s48, v15
    s_nop 6
    ds_write_b128 v2, v[144:147] offset:0
    ds_write_b128 v2, v[148:151] offset:1024
    ds_write_b128 v2, v[152:155] offset:2048
    ds_write_b128 v2, v[156:159] offset:3072
    s_add_u32 s80, s80, 2048
    s_cmp_eq_u32 s80, s70
    s_cselect_b32 s80, s81, s80
    buffer_load_dwordx4 a[220:223], v21, s[76:79], s80 offen sc1
    s_waitcnt lgkmcnt(0)
    s_barrier
    v_mfma_f32_32x32x16_bf16 v[96:111], a[112:115], a[16:19], v[96:111]
    ds_read_b128 a[136:139], v198 offset:33024
    buffer_load_dwordx4 v15, s[20:23], s43 offen offset:0 lds
    v_mfma_f32_16x16x32_bf16 a[144:147], a[160:163], a[112:115], a[144:147]
    v_mfma_f32_32x32x16_bf16 v[112:127], a[116:119], a[16:19], v[112:127]
    ds_read_b128 a[140:143], v198 offset:34048
    s_lshl_b32 s48, s38, 10
    s_add_u32 s48, s48, 145920
    v_add_u32 v2, s48, v15
    ds_read_b128 v[144:147], v2 offset:0
    ds_read_b128 v[148:151], v2 offset:4096
    ds_read_b128 v[152:155], v2 offset:8192
    ds_read_b128 v[156:159], v2 offset:12288
    s_waitcnt lgkmcnt(2)
    v_add_f32 v144, v144, v148
    v_add_f32 v145, v145, v149
    buffer_load_dwordx4 a[224:227], v28, s[76:79], s80 offen sc1
    v_mfma_f32_16x16x32_bf16 a[148:151], a[160:163], a[116:119], a[148:151]
    v_add_f32 v146, v146, v150
    v_add_f32 v147, v147, v151
    v_mfma_f32_32x32x16_bf16 v[128:143], a[120:123], a[16:19], v[128:143]
    ds_read_b128 a[112:115], v198 offset:35072
    buffer_load_dwordx4 v15, s[20:23], s43 offen offset:1024 lds
    s_waitcnt lgkmcnt(1)
    v_add_f32 v152, v152, v156
    v_add_f32 v153, v153, v157
    v_add_f32 v154, v154, v158
    v_add_f32 v155, v155, v159
    v_add_f32 v144, v144, v152
    v_mfma_f32_16x16x32_bf16 a[152:155], a[160:163], a[120:123], a[152:155]
    v_add_f32 v145, v145, v153
    v_add_f32 v146, v146, v154
    v_add_f32 v147, v147, v155
    v_mfma_f32_32x32x16_bf16 v[96:111], a[124:127], a[20:23], v[96:111]
    ds_read_b128 a[116:119], v199 offset:33024
    v_cvt_pk_bf16_f32 v148, v144, v145
    v_cvt_pk_bf16_f32 v149, v146, v147
    v_mfma_f32_32x32x16_bf16 v[112:127], a[128:131], a[20:23], v[112:127]
    ds_read_b128 a[120:123], v199 offset:34048
    s_lshl_b32 s51, s37, 3
    s_lshr_b32 s50, s36, 1
    s_add_u32 s51, s51, s50
    s_lshl_b32 s51, s51, 2
    s_add_u32 s51, s51, s38
    s_lshl_b32 s51, s51, 10
    s_and_b32 s50, s36, 1
    s_lshl_b32 s50, s50, 3
    s_add_u32 s51, s51, s50
    buffer_store_dwordx2 v[148:149], v15, s[32:35], s51 offen sc1
    s_add_u32 s80, s80, 2048
    s_cmp_eq_u32 s80, s70
    s_cselect_b32 s80, s81, s80
    buffer_load_dwordx4 a[228:231], v21, s[76:79], s80 offen sc1
    v_mfma_f32_32x32x16_bf16 v[128:143], a[132:135], a[20:23], v[128:143]
    ds_read_b128 a[124:127], v199 offset:35072
    buffer_load_dwordx4 v15, s[20:23], s43 offen offset:2048 lds
    s_add_u32 s43, s43, 12288
    s_cmp_eq_u32 s59, 6
    s_cselect_b32 s48, 86016, 0
    s_sub_u32 s43, s43, s48
    s_add_u32 s59, s59, 1
    s_add_u32 m0, s41, 49536
    v_mfma_f32_32x32x16_bf16 v[96:111], a[136:139], a[24:27], v[96:111]
    ds_read_b128 a[128:131], v196 offset:49536
    v_add_f32 v216, v216, v217
    buffer_load_dwordx4 a[232:235], v28, s[76:79], s80 offen sc1
    v_mfma_f32_32x32x16_bf16 v[112:127], a[140:143], a[24:27], v[112:127]
    ds_read_b128 a[132:135], v196 offset:50560
    s_waitcnt lgkmcnt(5)
    v_mfma_f32_32x32x16_bf16 v[128:143], a[112:115], a[24:27], v[128:143]
    ds_read_b128 a[136:139], v196 offset:51584
    v_subrev_u32 v196, 66048, v196
    s_add_u32 s80, s80, 2048
    s_cmp_eq_u32 s80, s70
    s_cselect_b32 s80, s81, s80
    buffer_load_dwordx4 a[236:239], v21, s[76:79], s80 offen sc1
    s_waitcnt lgkmcnt(5)
    v_mfma_f32_32x32x16_bf16 v[96:111], a[116:119], a[28:31], v[96:111]
    ds_read_b128 a[140:143], v197 offset:49536
    v_add_f32 v218, v218, v219
    s_waitcnt lgkmcnt(5)
    v_mfma_f32_32x32x16_bf16 v[112:127], a[120:123], a[28:31], v[112:127]
    ds_read_b128 a[112:115], v197 offset:50560
    s_waitcnt lgkmcnt(5)
    v_mfma_f32_32x32x16_bf16 v[128:143], a[124:127], a[28:31], v[128:143]
    ds_read_b128 a[116:119], v197 offset:51584
    v_subrev_u32 v197, 66048, v197
    buffer_load_dwordx4 a[240:243], v28, s[76:79], s80 offen sc1
    s_waitcnt lgkmcnt(5)
    v_mfma_f32_32x32x16_bf16 v[96:111], a[128:131], a[32:35], v[96:111]
    ds_read_b128 a[120:123], v198 offset:49536
    buffer_load_dwordx4 v15, s[20:23], s43 offen offset:0 lds
    v_add_f32 v216, v216, v218
    v_mfma_f32_16x16x32_bf16 a[144:147], a[160:163], a[128:131], a[144:147]
    s_waitcnt lgkmcnt(5)
    v_mfma_f32_32x32x16_bf16 v[112:127], a[132:135], a[32:35], v[112:127]
    ds_read_b128 a[124:127], v198 offset:50560
    s_add_u32 s80, s80, 2048
    s_cmp_eq_u32 s80, s70
    s_cselect_b32 s80, s81, s80
    buffer_load_dwordx4 a[244:247], v21, s[76:79], s80 offen sc1
    v_mfma_f32_16x16x32_bf16 a[148:151], a[160:163], a[132:135], a[148:151]
    s_waitcnt lgkmcnt(5)
    v_mfma_f32_32x32x16_bf16 v[128:143], a[136:139], a[32:35], v[128:143]
    ds_read_b128 a[128:131], v198 offset:51584
    v_subrev_u32 v198, 66048, v198
    buffer_load_dwordx4 v15, s[20:23], s43 offen offset:1024 lds
    v_cvt_pk_bf16_f32 v217, v216, v216
    v_mfma_f32_16x16x32_bf16 a[152:155], a[160:163], a[136:139], a[152:155]
    s_waitcnt lgkmcnt(5)
    v_mfma_f32_32x32x16_bf16 v[96:111], a[140:143], a[36:39], v[96:111]
    ds_read_b128 a[132:135], v199 offset:49536
    buffer_load_dwordx4 a[248:251], v28, s[76:79], s80 offen sc1
    s_waitcnt lgkmcnt(5)
    v_mfma_f32_32x32x16_bf16 v[112:127], a[112:115], a[36:39], v[112:127]
    ds_read_b128 a[136:139], v199 offset:50560
    s_waitcnt lgkmcnt(5)
    v_mfma_f32_32x32x16_bf16 v[128:143], a[116:119], a[36:39], v[128:143]
    ds_read_b128 a[140:143], v199 offset:51584
    v_subrev_u32 v199, 66048, v199
    buffer_load_dwordx4 v15, s[20:23], s43 offen offset:2048 lds
    v_and_b32 v217, s47, v217
    s_waitcnt vmcnt(17) lgkmcnt(0)
    s_barrier
    v_mfma_f32_32x32x16_bf16 v[96:111], a[120:123], a[40:43], v[96:111]
    ds_read_b128 a[112:115], v196 offset:0
    s_add_u32 s80, s80, 2048
    s_cmp_eq_u32 s80, s70
    s_cselect_b32 s80, s81, s80
    buffer_load_dwordx4 a[0:3], v21, s[76:79], s80 offen sc1
    v_mfma_f32_32x32x16_bf16 v[112:127], a[124:127], a[40:43], v[112:127]
    ds_read_b128 a[116:119], v196 offset:1024
    buffer_load_dwordx4 a[4:7], v28, s[76:79], s80 offen sc1
    v_mfma_f32_32x32x16_bf16 v[128:143], a[128:131], a[40:43], v[128:143]
    ds_read_b128 a[120:123], v196 offset:2048
    v_sub_f32 v216, v216, v217
    v_mfma_f32_32x32x16_bf16 v[96:111], a[132:135], a[44:47], v[96:111]
    ds_read_b128 a[124:127], v197 offset:0
    s_add_u32 s80, s80, 2048
    s_cmp_eq_u32 s80, s70
    s_cselect_b32 s80, s81, s80
    buffer_load_dwordx4 a[8:11], v21, s[76:79], s80 offen sc1
    v_mfma_f32_32x32x16_bf16 v[112:127], a[136:139], a[44:47], v[112:127]
    ds_read_b128 a[128:131], v197 offset:1024
    v_mfma_f32_32x32x16_bf16 v[128:143], a[140:143], a[44:47], v[128:143]
    ds_read_b128 a[132:135], v197 offset:2048
    v_cvt_pk_bf16_f32 v208, v217, v216
    buffer_load_dwordx4 a[12:15], v28, s[76:79], s80 offen sc1
    s_waitcnt lgkmcnt(5)
    v_mfma_f32_32x32x16_bf16 v[96:111], a[112:115], a[48:51], v[96:111]
    ds_read_b128 a[136:139], v198 offset:0
    s_waitcnt vmcnt(14)
    s_lshl_b32 s50, s37, 8
    s_lshl_b32 s51, s36, 4
    s_add_u32 s50, s50, s51
    s_lshl_b32 s51, s38, 2
    s_add_u32 s50, s50, s51
    s_add_u32 s50, s50, 8192
    v_mov_b32 v2, s50
    v_mov_b32 v3, s75
    s_mov_b64 exec, 1
    buffer_store_dword v3, v2, s[60:63], 0 offen sc1
    s_mov_b64 exec, -1
    v_mfma_f32_16x16x32_bf16 a[144:147], a[160:163], a[112:115], a[144:147]
    s_waitcnt lgkmcnt(5)
    v_mfma_f32_32x32x16_bf16 v[112:127], a[116:119], a[48:51], v[112:127]
    ds_read_b128 a[140:143], v198 offset:1024
    s_add_u32 s80, s80, 2048
    s_cmp_eq_u32 s80, s70
    s_cselect_b32 s80, s81, s80
    buffer_load_dwordx4 a[16:19], v21, s[76:79], s80 offen sc1
    v_mfma_f32_16x16x32_bf16 a[148:151], a[160:163], a[116:119], a[148:151]
    s_waitcnt lgkmcnt(5)
    v_mfma_f32_32x32x16_bf16 v[128:143], a[120:123], a[48:51], v[128:143]
    ds_read_b128 a[112:115], v198 offset:2048
    v_mfma_f32_32x32x16_bf16 v[176:191], v[208:211], v[204:207], v[176:191]
    v_mfma_f32_16x16x32_bf16 a[152:155], a[160:163], a[120:123], a[152:155]
    s_waitcnt lgkmcnt(5)
    v_mfma_f32_32x32x16_bf16 v[96:111], a[124:127], a[52:55], v[96:111]
    ds_read_b128 a[116:119], v199 offset:0
    buffer_load_dwordx4 a[20:23], v28, s[76:79], s80 offen sc1
    s_waitcnt lgkmcnt(5)
    v_mfma_f32_32x32x16_bf16 v[112:127], a[128:131], a[52:55], v[112:127]
    ds_read_b128 a[120:123], v199 offset:1024
    s_waitcnt lgkmcnt(5)
    v_mfma_f32_32x32x16_bf16 v[128:143], a[132:135], a[52:55], v[128:143]
    ds_read_b128 a[124:127], v199 offset:2048
    s_nop 0
    v_fma_f32 v234, v176, v23, v228
    v_fma_f32 v235, v177, v23, v228
    s_add_u32 s80, s80, 2048
    s_cmp_eq_u32 s80, s70
    s_cselect_b32 s80, s81, s80
    buffer_load_dwordx4 a[24:27], v21, s[76:79], s80 offen sc1
    s_waitcnt lgkmcnt(5)
    v_mfma_f32_32x32x16_bf16 v[96:111], a[136:139], a[56:59], v[96:111]
    ds_read_b128 a[128:131], v196 offset:16512
    v_fma_f32 v232, v234, v229, v230
    v_fma_f32 v233, v235, v229, v230
    s_waitcnt lgkmcnt(5)
    v_mfma_f32_32x32x16_bf16 v[112:127], a[140:143], a[56:59], v[112:127]
    ds_read_b128 a[132:135], v196 offset:17536
    v_exp_f32 v232, v232 clamp
    v_exp_f32 v233, v233 clamp
    buffer_load_dwordx4 a[28:31], v28, s[76:79], s80 offen sc1
    s_waitcnt lgkmcnt(5)
    v_mfma_f32_32x32x16_bf16 v[128:143], a[112:115], a[56:59], v[128:143]
    ds_read_b128 a[136:139], v196 offset:18560
    v_max_f32 v234, v228, v234
    v_max_f32 v235, v228, v235
    s_waitcnt lgkmcnt(5)
    v_mfma_f32_32x32x16_bf16 v[96:111], a[116:119], a[60:63], v[96:111]
    ds_read_b128 a[140:143], v197 offset:16512
    v_add_f32 v232, v232, v234
    v_add_f32 v233, v233, v235
    s_add_u32 s80, s80, 2048
    s_cmp_eq_u32 s80, s70
    s_cselect_b32 s80, s81, s80
    buffer_load_dwordx4 a[32:35], v21, s[76:79], s80 offen sc1
    s_waitcnt lgkmcnt(5)
    v_mfma_f32_32x32x16_bf16 v[112:127], a[120:123], a[60:63], v[112:127]
    ds_read_b128 a[112:115], v197 offset:17536
    v_cvt_pk_bf16_f32 v176, v232, v233
    v_fma_f32 v238, v178, v23, v228
    s_waitcnt lgkmcnt(5)
    v_mfma_f32_32x32x16_bf16 v[128:143], a[124:127], a[60:63], v[128:143]
    ds_read_b128 a[116:119], v197 offset:18560
    v_fma_f32 v239, v179, v23, v228
    v_fma_f32 v236, v238, v229, v230
    buffer_load_dwordx4 a[36:39], v28, s[76:79], s80 offen sc1
    s_waitcnt lgkmcnt(5)
    v_mfma_f32_32x32x16_bf16 v[96:111], a[128:131], a[64:67], v[96:111]
    ds_read_b128 a[120:123], v198 offset:16512
    v_fma_f32 v237, v239, v229, v230
    v_exp_f32 v236, v236 clamp
    v_mfma_f32_16x16x32_bf16 a[144:147], a[160:163], a[128:131], a[144:147]
    v_exp_f32 v237, v237 clamp
    s_waitcnt lgkmcnt(5)
    v_mfma_f32_32x32x16_bf16 v[112:127], a[132:135], a[64:67], v[112:127]
    ds_read_b128 a[124:127], v198 offset:17536
    v_max_f32 v238, v228, v238
    v_max_f32 v239, v228, v239
    buffer_load_dwordx4 a[40:43], v21, s[76:79], s71 offen sc1
    v_mfma_f32_16x16x32_bf16 a[148:151], a[160:163], a[132:135], a[148:151]
    s_waitcnt lgkmcnt(5)
    v_mfma_f32_32x32x16_bf16 v[128:143], a[136:139], a[64:67], v[128:143]
    ds_read_b128 a[128:131], v198 offset:18560
    v_add_f32 v236, v236, v238
    v_add_f32 v237, v237, v239
    v_mfma_f32_16x16x32_bf16 a[152:155], a[160:163], a[136:139], a[152:155]
    v_cvt_pk_bf16_f32 v177, v236, v237
    s_waitcnt lgkmcnt(5)
    v_mfma_f32_32x32x16_bf16 v[96:111], a[140:143], a[68:71], v[96:111]
    ds_read_b128 a[132:135], v199 offset:16512
    v_fma_f32 v234, v180, v23, v228
    v_fma_f32 v235, v181, v23, v228
    buffer_load_dwordx4 a[44:47], v28, s[76:79], s71 offen sc1
    s_waitcnt lgkmcnt(5)
    v_mfma_f32_32x32x16_bf16 v[112:127], a[112:115], a[68:71], v[112:127]
    ds_read_b128 a[136:139], v199 offset:17536
    v_fma_f32 v232, v234, v229, v230
    v_fma_f32 v233, v235, v229, v230
    s_waitcnt lgkmcnt(5)
    v_mfma_f32_32x32x16_bf16 v[128:143], a[116:119], a[68:71], v[128:143]
    ds_read_b128 a[140:143], v199 offset:18560
    v_exp_f32 v232, v232 clamp
    v_exp_f32 v233, v233 clamp
    s_add_u32 s71, s71, 2048
    s_cmp_eq_u32 s71, s82
    s_cselect_b32 s71, s70, s71
    buffer_load_dwordx4 a[48:51], v21, s[76:79], s71 offen sc1
    s_waitcnt vmcnt(14) lgkmcnt(0)
    s_barrier
    v_mfma_f32_32x32x16_bf16 v[96:111], a[120:123], a[72:75], v[96:111]
    ds_read_b128 a[112:115], v196 offset:33024
    v_max_f32 v234, v228, v234
    v_max_f32 v235, v228, v235
    v_mfma_f32_32x32x16_bf16 v[112:127], a[124:127], a[72:75], v[112:127]
    ds_read_b128 a[116:119], v196 offset:34048
    v_add_f32 v232, v232, v234
    v_add_f32 v233, v233, v235
    buffer_load_dwordx4 a[52:55], v28, s[76:79], s71 offen sc1
    v_mfma_f32_32x32x16_bf16 v[128:143], a[128:131], a[72:75], v[128:143]
    ds_read_b128 a[120:123], v196 offset:35072
    v_cvt_pk_bf16_f32 v178, v232, v233
    v_fma_f32 v238, v182, v23, v228
    v_and_b32 v29, 7, v1
    v_lshlrev_b32 v29, 2, v29
    s_lshl_b32 s48, s14, 7
    s_lshl_b32 s49, s38, 5
    s_add_u32 s48, s48, s49
    v_add_u32 v29, s48, v29
    buffer_load_dword v29, v29, s[60:63], 0 offen sc1
    v_mfma_f32_32x32x16_bf16 v[96:111], a[132:135], a[76:79], v[96:111]
    ds_read_b128 a[124:127], v197 offset:33024
    v_fma_f32 v239, v183, v23, v228
    v_fma_f32 v236, v238, v229, v230
    s_add_u32 s71, s71, 2048
    s_cmp_eq_u32 s71, s82
    s_cselect_b32 s71, s70, s71
    buffer_load_dwordx4 a[56:59], v21, s[76:79], s71 offen sc1
    v_mfma_f32_32x32x16_bf16 v[112:127], a[136:139], a[76:79], v[112:127]
    ds_read_b128 a[128:131], v197 offset:34048
    v_fma_f32 v237, v239, v229, v230
    v_exp_f32 v236, v236 clamp
    buffer_load_dwordx4 a[60:63], v28, s[76:79], s71 offen sc1
    v_mfma_f32_32x32x16_bf16 v[128:143], a[140:143], a[76:79], v[128:143]
    ds_read_b128 a[132:135], v197 offset:35072
    v_exp_f32 v237, v237 clamp
    v_max_f32 v238, v228, v238
    s_waitcnt lgkmcnt(5)
    v_mfma_f32_32x32x16_bf16 v[96:111], a[112:115], a[80:83], v[96:111]
    ds_read_b128 a[136:139], v198 offset:33024
    v_max_f32 v239, v228, v239
    v_add_f32 v236, v236, v238
    s_add_u32 s71, s71, 2048
    s_cmp_eq_u32 s71, s82
    s_cselect_b32 s71, s70, s71
    buffer_load_dwordx4 a[64:67], v21, s[76:79], s71 offen sc1
    v_mfma_f32_16x16x32_bf16 a[144:147], a[160:163], a[112:115], a[144:147]
    v_add_f32 v237, v237, v239
    s_waitcnt lgkmcnt(5)
    v_mfma_f32_32x32x16_bf16 v[112:127], a[116:119], a[80:83], v[112:127]
    ds_read_b128 a[140:143], v198 offset:34048
    v_cvt_pk_bf16_f32 v179, v236, v237
    v_fma_f32 v234, v184, v23, v228
    v_mfma_f32_16x16x32_bf16 a[148:151], a[160:163], a[116:119], a[148:151]
    v_fma_f32 v235, v185, v23, v228
    s_waitcnt lgkmcnt(5)
    v_mfma_f32_32x32x16_bf16 v[128:143], a[120:123], a[80:83], v[128:143]
    ds_read_b128 a[112:115], v198 offset:35072
    v_fma_f32 v232, v234, v229, v230
    v_fma_f32 v233, v235, v229, v230
    buffer_load_dwordx4 a[68:71], v28, s[76:79], s71 offen sc1
    v_mfma_f32_16x16x32_bf16 a[152:155], a[160:163], a[120:123], a[152:155]
    s_waitcnt lgkmcnt(5)
    v_mfma_f32_32x32x16_bf16 v[96:111], a[124:127], a[84:87], v[96:111]
    ds_read_b128 a[116:119], v199 offset:33024
    v_exp_f32 v232, v232 clamp
    v_exp_f32 v233, v233 clamp
    s_waitcnt lgkmcnt(5)
    v_mfma_f32_32x32x16_bf16 v[112:127], a[128:131], a[84:87], v[112:127]
    ds_read_b128 a[120:123], v199 offset:34048
    v_max_f32 v234, v228, v234
    v_max_f32 v235, v228, v235
    s_add_u32 s71, s71, 2048
    s_cmp_eq_u32 s71, s82
    s_cselect_b32 s71, s70, s71
    buffer_load_dwordx4 a[72:75], v21, s[76:79], s71 offen sc1
    s_waitcnt lgkmcnt(5)
    v_mfma_f32_32x32x16_bf16 v[128:143], a[132:135], a[84:87], v[128:143]
    ds_read_b128 a[124:127], v199 offset:35072
    v_add_f32 v232, v232, v234
    v_add_f32 v233, v233, v235
    s_waitcnt lgkmcnt(5)
    v_mfma_f32_32x32x16_bf16 v[96:111], a[136:139], a[88:91], v[96:111]
    ds_read_b128 a[128:131], v196 offset:49536
    v_cvt_pk_bf16_f32 v180, v232, v233
    v_fma_f32 v238, v186, v23, v228
    buffer_load_dwordx4 a[76:79], v28, s[76:79], s71 offen sc1
    s_waitcnt lgkmcnt(5)
    v_mfma_f32_32x32x16_bf16 v[112:127], a[140:143], a[88:91], v[112:127]
    ds_read_b128 a[132:135], v196 offset:50560
    v_fma_f32 v239, v187, v23, v228
    v_fma_f32 v236, v238, v229, v230
    s_waitcnt lgkmcnt(5)
    v_mfma_f32_32x32x16_bf16 v[128:143], a[112:115], a[88:91], v[128:143]
    ds_read_b128 a[136:139], v196 offset:51584
    v_fma_f32 v237, v239, v229, v230
    v_exp_f32 v236, v236 clamp
    s_add_u32 s71, s71, 2048
    s_cmp_eq_u32 s71, s82
    s_cselect_b32 s71, s70, s71
    buffer_load_dwordx4 a[80:83], v21, s[76:79], s71 offen sc1
    s_waitcnt lgkmcnt(5)
    v_mfma_f32_32x32x16_bf16 v[96:111], a[116:119], a[92:95], v[96:111]
    ds_read_b128 a[140:143], v197 offset:49536
    v_exp_f32 v237, v237 clamp
    v_max_f32 v238, v228, v238
    s_waitcnt lgkmcnt(5)
    v_mfma_f32_32x32x16_bf16 v[112:127], a[120:123], a[92:95], v[112:127]
    ds_read_b128 a[112:115], v197 offset:50560
    v_max_f32 v239, v228, v239
    v_add_f32 v236, v236, v238
    buffer_load_dwordx4 a[84:87], v28, s[76:79], s71 offen sc1
    s_waitcnt lgkmcnt(5)
    v_mfma_f32_32x32x16_bf16 v[128:143], a[124:127], a[92:95], v[128:143]
    ds_read_b128 a[116:119], v197 offset:51584
    v_add_f32 v237, v237, v239
    v_cvt_pk_bf16_f32 v181, v236, v237
    s_waitcnt lgkmcnt(5)
    v_mfma_f32_32x32x16_bf16 v[96:111], a[128:131], a[96:99], v[96:111]
    ds_read_b128 a[120:123], v198 offset:49536
    v_fma_f32 v234, v188, v23, v228
    v_fma_f32 v235, v189, v23, v228
    s_add_u32 s71, s71, 2048
    s_cmp_eq_u32 s71, s82
    s_cselect_b32 s71, s70, s71
    buffer_load_dwordx4 a[88:91], v21, s[76:79], s71 offen sc1
    v_mfma_f32_16x16x32_bf16 a[144:147], a[160:163], a[128:131], a[144:147]
    v_fma_f32 v232, v234, v229, v230
    s_waitcnt lgkmcnt(5)
    v_mfma_f32_32x32x16_bf16 v[112:127], a[132:135], a[96:99], v[112:127]
    ds_read_b128 a[124:127], v198 offset:50560
    v_fma_f32 v233, v235, v229, v230
    v_exp_f32 v232, v232 clamp
    v_mfma_f32_16x16x32_bf16 a[148:151], a[160:163], a[132:135], a[148:151]
    v_exp_f32 v233, v233 clamp
    s_waitcnt lgkmcnt(5)
    v_mfma_f32_32x32x16_bf16 v[128:143], a[136:139], a[96:99], v[128:143]
    ds_read_b128 a[128:131], v198 offset:51584
    v_max_f32 v234, v228, v234
    v_max_f32 v235, v228, v235
    buffer_load_dwordx4 a[92:95], v28, s[76:79], s71 offen sc1
    v_mfma_f32_16x16x32_bf16 a[152:155], a[160:163], a[136:139], a[152:155]
    v_add_f32 v232, v232, v234
    v_lshrrev_b32 v2, 3, v1
    v_mul_u32_u24 v2, 896, v2
    v_and_b32 v3, 7, v1
    v_lshl_add_u32 v2, v3, 4, v2
    s_lshl_b32 s48, s14, 2
    s_add_u32 s48, s48, s38
    s_mul_i32 s48, s48, 14336
    s_lshl_b32 s49, s15, 7
    s_add_u32 s48, s48, s49
    v_add_u32 v2, s48, v2
    s_movk_i32 s48, 7168
    buffer_load_dwordx4 v[240:243], v2, s[24:27], 0 offen
    buffer_load_dwordx4 v[244:247], v2, s[24:27], s48 offen
    s_waitcnt lgkmcnt(5)
    v_mfma_f32_32x32x16_bf16 v[96:111], a[140:143], a[100:103], v[96:111]
    ds_read_b128 a[132:135], v199 offset:49536
    v_add_f32 v233, v233, v235
    v_cvt_pk_bf16_f32 v182, v232, v233
    s_waitcnt lgkmcnt(5)
    v_mfma_f32_32x32x16_bf16 v[112:127], a[112:115], a[100:103], v[112:127]
    ds_read_b128 a[136:139], v199 offset:50560
    v_accvgpr_read_b32 v200, a144
    ds_write_b32 v225, v200 offset:2048
    v_accvgpr_read_b32 v201, a148
    ds_write_b32 v225, v201 offset:2560
    s_waitcnt lgkmcnt(7)
    v_mfma_f32_32x32x16_bf16 v[128:143], a[116:119], a[100:103], v[128:143]
    ds_read_b128 a[140:143], v199 offset:51584
    v_accvgpr_read_b32 v202, a152
    ds_write_b32 v225, v202 offset:3072
    v_fma_f32 v238, v190, v23, v228
    s_add_u32 s71, s71, 2048
    s_cmp_eq_u32 s71, s82
    s_cselect_b32 s71, s70, s71
    buffer_load_dwordx4 a[96:99], v21, s[76:79], s71 offen sc1
    s_waitcnt lgkmcnt(0)
    s_barrier
    v_mfma_f32_32x32x16_bf16 v[96:111], a[120:123], a[104:107], v[96:111]
    v_fma_f32 v239, v191, v23, v228
    v_fma_f32 v236, v238, v229, v230
    buffer_load_dwordx4 a[100:103], v28, s[76:79], s71 offen sc1
    v_mfma_f32_32x32x16_bf16 v[112:127], a[124:127], a[104:107], v[112:127]
    v_fma_f32 v237, v239, v229, v230
    v_exp_f32 v236, v236 clamp
    v_exp_f32 v237, v237 clamp
    v_mfma_f32_32x32x16_bf16 v[128:143], a[128:131], a[104:107], v[128:143]
    v_max_f32 v238, v228, v238
    v_max_f32 v239, v228, v239
    v_mfma_f32_32x32x16_bf16 v[96:111], a[132:135], a[108:111], v[96:111]
    v_add_f32 v236, v236, v238
    v_add_f32 v237, v237, v239
    v_cvt_pk_bf16_f32 v183, v236, v237
    ds_read_b128 v[216:219], v226 offset:2048
    ds_read_b128 v[220:223], v226 offset:2560
    v_mfma_f32_32x32x16_bf16 v[112:127], a[136:139], a[108:111], v[112:127]
    v_cndmask_b32 v182, 0, v182, s[54:55]
    v_cndmask_b32 v183, 0, v183, s[54:55]
    v_mfma_f32_32x32x16_bf16 v[128:143], a[140:143], a[108:111], v[128:143]
    s_add_u32 s71, s71, 2048
    s_cmp_eq_u32 s71, s82
    s_cselect_b32 s71, s70, s71
    buffer_load_dwordx4 a[104:107], v21, s[76:79], s71 offen sc1
    buffer_load_dwordx4 a[108:111], v28, s[76:79], s71 offen sc1
    s_mul_i32 s48, s14, 294912
    s_mul_i32 s49, s38, 28672
    s_add_u32 s57, s48, s49
    s_add_u32 s58, s57, 28672
    s_add_u32 s46, s57, 16384
    s_lshl_b32 s49, s38, 13
    s_add_u32 s59, s48, s49
    s_add_u32 s59, s59, 114688
    s_lshl_b32 s49, s68, 10
    s_add_u32 s56, s57, s49
    s_lshl_b32 s49, s69, 10
    s_add_u32 s74, s46, s49
    v_mov_b32 v4, v15
    v_add_u32 v5, 147456, v15
    buffer_load_dword v27, v27, s[60:63], 0 offen sc1
    s_waitcnt vmcnt(17)
    v_cmp_ne_u32 vcc, s75, v29
    s_nop 0
    s_cbranch_vccnz L_slowA_9
L_okA_10:
    s_waitcnt lgkmcnt(1)
    v_add_f32 v216, v216, v217
    v_add_f32 v218, v218, v219
    v_add_f32 v216, v216, v218
    v_cvt_pk_bf16_f32 v217, v216, v216
    v_and_b32 v217, s47, v217
    v_sub_f32 v216, v216, v217
    v_cvt_pk_bf16_f32 v208, v217, v216
    s_nop 1
    v_mfma_f32_32x32x16_bf16 v[96:111], v[208:211], v[204:207], v[96:111]
    ds_read_b128 v[216:219], v226 offset:3072
    s_nop 10
    v_max_f32 v96, 0, v96
    buffer_load_dwordx4 v[192:195], v4, s[28:31], s56 offen sc1
    v_mul_f32 v104, v224, v104
    v_max_f32 v97, 0, v97
    v_mul_f32 v105, v224, v105
    v_mul_f32 v96, v96, v104
    v_mul_f32 v97, v97, v105
    v_cvt_pk_bf16_f32 v96, v96, v97
    v_max_f32 v98, 0, v98
    v_mul_f32 v106, v224, v106
    v_max_f32 v99, 0, v99
    buffer_load_dwordx4 v[196:199], v5, s[28:31], s56 offen sc1
    v_mul_f32 v107, v224, v107
    v_mul_f32 v98, v98, v106
    v_mul_f32 v99, v99, v107
    v_cvt_pk_bf16_f32 v97, v98, v99
    v_max_f32 v100, 0, v100
    v_mul_f32 v108, v224, v108
    v_max_f32 v101, 0, v101
    v_mul_f32 v109, v224, v109
    v_mul_f32 v100, v100, v108
    v_mul_f32 v101, v101, v109
    s_add_u32 s56, s56, 1024
    s_cmp_eq_u32 s56, s46
    s_cselect_b32 s56, s57, s56
    buffer_load_dwordx4 v[228:231], v4, s[28:31], s56 offen sc1
    v_cvt_pk_bf16_f32 v98, v100, v101
    v_max_f32 v102, 0, v102
    v_mul_f32 v110, v224, v110
    v_max_f32 v103, 0, v103
    v_mul_f32 v111, v224, v111
    v_mul_f32 v102, v102, v110
    v_mul_f32 v103, v103, v111
    v_cvt_pk_bf16_f32 v99, v102, v103
    s_bfe_u32 s50, s72, 0x50000
    s_lshl_b32 s50, s50, 10
    s_add_u32 s50, s50, s45
    buffer_store_dwordx4 v[96:99], v15, s[28:31], s50 offen sc1
    buffer_load_dwordx4 v[232:235], v5, s[28:31], s56 offen sc1
    s_waitcnt lgkmcnt(1)
    v_add_f32 v220, v220, v221
    v_add_f32 v222, v222, v223
    v_add_f32 v220, v220, v222
    v_cvt_pk_bf16_f32 v221, v220, v220
    v_and_b32 v221, s47, v221
    v_sub_f32 v220, v220, v221
    v_cvt_pk_bf16_f32 v212, v221, v220
    s_nop 1
    v_mfma_f32_32x32x16_bf16 v[112:127], v[212:215], v[204:207], v[112:127]
    s_nop 11
    v_max_f32 v112, 0, v112
    v_mul_f32 v120, v224, v120
    s_add_u32 s56, s56, 1024
    s_cmp_eq_u32 s56, s46
    s_cselect_b32 s56, s57, s56
    buffer_load_dwordx4 v[96:99], v4, s[28:31], s56 offen sc1
    v_max_f32 v113, 0, v113
    v_mul_f32 v121, v224, v121
    v_mul_f32 v112, v112, v120
    v_mul_f32 v113, v113, v121
    v_cvt_pk_bf16_f32 v112, v112, v113
    v_max_f32 v114, 0, v114
    v_mul_f32 v122, v224, v122
    v_max_f32 v115, 0, v115
    v_mul_f32 v123, v224, v123
    buffer_load_dwordx4 v[100:103], v5, s[28:31], s56 offen sc1
    v_mul_f32 v114, v114, v122
    v_mul_f32 v115, v115, v123
    v_cvt_pk_bf16_f32 v113, v114, v115
    v_max_f32 v116, 0, v116
    v_mul_f32 v124, v224, v124
    v_max_f32 v117, 0, v117
    v_mul_f32 v125, v224, v125
    v_mul_f32 v116, v116, v124
    v_mul_f32 v117, v117, v125
    s_add_u32 s56, s56, 1024
    s_cmp_eq_u32 s56, s46
    s_cselect_b32 s56, s57, s56
    buffer_load_dwordx4 v[104:107], v4, s[28:31], s56 offen sc1
    v_cvt_pk_bf16_f32 v114, v116, v117
    v_max_f32 v118, 0, v118
    v_mul_f32 v126, v224, v126
    v_max_f32 v119, 0, v119
    v_mul_f32 v127, v224, v127
    v_mul_f32 v118, v118, v126
    v_mul_f32 v119, v119, v127
    v_cvt_pk_bf16_f32 v115, v118, v119
    s_bfe_u32 s50, s72, 0x50005
    s_lshl_b32 s50, s50, 10
    s_add_u32 s50, s50, s45
    buffer_store_dwordx4 v[112:115], v15, s[28:31], s50 offen sc1
    buffer_load_dwordx4 v[108:111], v5, s[28:31], s56 offen sc1
    s_waitcnt lgkmcnt(0)
    v_add_f32 v216, v216, v217
    v_add_f32 v218, v218, v219
    v_add_f32 v216, v216, v218
    v_cvt_pk_bf16_f32 v217, v216, v216
    v_and_b32 v217, s47, v217
    v_sub_f32 v216, v216, v217
    v_cvt_pk_bf16_f32 v208, v217, v216
    s_nop 1
    v_mfma_f32_32x32x16_bf16 v[128:143], v[208:211], v[204:207], v[128:143]
    s_nop 11
    v_max_f32 v128, 0, v128
    v_mul_f32 v136, v224, v136
    s_add_u32 s56, s56, 1024
    s_cmp_eq_u32 s56, s46
    s_cselect_b32 s56, s57, s56
    buffer_load_dwordx4 v[112:115], v4, s[28:31], s56 offen sc1
    v_max_f32 v129, 0, v129
    v_mul_f32 v137, v224, v137
    v_mul_f32 v128, v128, v136
    v_mul_f32 v129, v129, v137
    v_cvt_pk_bf16_f32 v128, v128, v129
    v_max_f32 v130, 0, v130
    v_mul_f32 v138, v224, v138
    v_max_f32 v131, 0, v131
    v_mul_f32 v139, v224, v139
    buffer_load_dwordx4 v[116:119], v5, s[28:31], s56 offen sc1
    v_mul_f32 v130, v130, v138
    v_mul_f32 v131, v131, v139
    v_cvt_pk_bf16_f32 v129, v130, v131
    v_max_f32 v132, 0, v132
    v_mul_f32 v140, v224, v140
    v_max_f32 v133, 0, v133
    v_mul_f32 v141, v224, v141
    v_mul_f32 v132, v132, v140
    v_mul_f32 v133, v133, v141
    s_add_u32 s56, s56, 1024
    s_cmp_eq_u32 s56, s46
    s_cselect_b32 s56, s57, s56
    buffer_load_dwordx4 v[120:123], v4, s[28:31], s56 offen sc1
    v_cvt_pk_bf16_f32 v130, v132, v133
    v_max_f32 v134, 0, v134
    v_mul_f32 v142, v224, v142
    v_max_f32 v135, 0, v135
    v_mul_f32 v143, v224, v143
    v_mul_f32 v134, v134, v142
    v_mul_f32 v135, v135, v143
    v_cvt_pk_bf16_f32 v131, v134, v135
    s_bfe_u32 s50, s72, 0x5000a
    s_lshl_b32 s50, s50, 10
    s_add_u32 s50, s50, s45
    buffer_store_dwordx4 v[128:131], v15, s[28:31], s50 offen sc1
    buffer_load_dwordx4 v[124:127], v5, s[28:31], s56 offen sc1
    s_cmp_eq_u32 s15, 7
    s_cbranch_scc1 L_noph2_11
    s_waitcnt vmcnt(14)
    v_mfma_f32_32x32x16_bf16 v[32:47], a[164:167], v[192:195], 0
    v_cmp_ne_u32 vcc, s75, v27
    s_nop 0
    s_cbranch_vccnz L_slowK_12
L_okK_13:
    v_mfma_f32_32x32x16_bf16 v[64:79], a[168:171], v[192:195], 0
    s_add_u32 s56, s56, 1024
    s_cmp_eq_u32 s56, s46
    s_cselect_b32 s56, s57, s56
    buffer_load_dwordx4 v[128:131], v4, s[28:31], s56 offen sc1
    buffer_load_dwordx4 v[132:135], v5, s[28:31], s56 offen sc1
    s_add_u32 s56, s56, 1024
    s_cmp_eq_u32 s56, s46
    s_cselect_b32 s56, s57, s56
    buffer_load_dwordx4 v[136:139], v4, s[28:31], s56 offen sc1
    buffer_load_dwordx4 v[140:143], v5, s[28:31], s56 offen sc1
    s_lshl_b32 s48, s37, 15
    s_lshl_b32 s49, s38, 10
    s_add_u32 s64, s48, s49
    buffer_load_dwordx4 v[144:147], v15, s[32:35], s64 offen sc1
    s_add_u32 s64, s64, 4096
    v_lshrrev_b32 v2, 4, v1
    v_bfe_u32 v3, v1, 2, 2
    v_cmp_eq_u32 vcc, v2, v3
    v_and_b32 v2, 1, v1
    v_lshlrev_b32 v2, 4, v2
    v_mov_b32 v3, 0x3f80
    v_lshlrev_b32 v3, v2, v3
    v_cndmask_b32 v3, 0, v3, vcc
    v_and_b32 v2, 2, v1
    v_cmp_eq_u32 vcc, 0, v2
    s_nop 1
    v_cndmask_b32 v200, 0, v3, vcc
    v_cndmask_b32 v201, v3, 0, vcc
    v_mov_b32 v202, v200
    v_mov_b32 v203, v201
    s_waitcnt vmcnt(18)
    v_mfma_f32_32x32x16_bf16 v[48:63], a[164:167], v[196:199], 0
    buffer_load_dwordx4 v[148:151], v15, s[32:35], s64 offen sc1
    s_add_u32 s64, s64, 4096
    v_mfma_f32_32x32x16_bf16 v[80:95], a[168:171], v[196:199], 0
    buffer_load_dwordx4 v[152:155], v15, s[32:35], s64 offen sc1
    s_add_u32 s64, s64, 4096
    s_waitcnt vmcnt(19)
    v_mfma_f32_32x32x16_bf16 v[32:47], a[172:175], v[228:231], v[32:47]
    buffer_load_dwordx4 v[156:159], v15, s[32:35], s64 offen sc1
    s_add_u32 s64, s64, 4096
    buffer_load_dwordx4 v[160:163], v15, s[32:35], s64 offen sc1
    s_add_u32 s64, s64, 4096
    v_mfma_f32_32x32x16_bf16 v[64:79], a[176:179], v[228:231], v[64:79]
    s_add_u32 s56, s56, 1024
    s_cmp_eq_u32 s56, s46
    s_cselect_b32 s56, s57, s56
    buffer_load_dwordx4 v[192:195], v4, s[28:31], s56 offen sc1
    buffer_load_dwordx4 v[196:199], v5, s[28:31], s56 offen sc1
    s_add_u32 s56, s56, 1024
    s_cmp_eq_u32 s56, s46
    s_cselect_b32 s56, s57, s56
    buffer_load_dwordx4 v[228:231], v4, s[28:31], s56 offen sc1
    buffer_load_dwordx4 v[164:167], v15, s[32:35], s64 offen sc1
    s_add_u32 s64, s64, 4096
    s_waitcnt vmcnt(23)
    v_mfma_f32_32x32x16_bf16 v[48:63], a[172:175], v[232:235], v[48:63]
    buffer_load_dwordx4 v[168:171], v15, s[32:35], s64 offen sc1
    s_add_u32 s64, s64, 4096
    v_mfma_f32_32x32x16_bf16 v[80:95], a[176:179], v[232:235], v[80:95]
    buffer_load_dwordx4 v[232:235], v5, s[28:31], s56 offen sc1
    buffer_load_dwordx4 v[172:175], v15, s[32:35], s64 offen sc1
    s_waitcnt vmcnt(25)
    v_mfma_f32_32x32x16_bf16 v[32:47], a[180:183], v[96:99], v[32:47]
    v_mfma_f32_32x32x16_bf16 v[64:79], a[184:187], v[96:99], v[64:79]
    s_add_u32 s56, s56, 1024
    s_cmp_eq_u32 s56, s46
    s_cselect_b32 s56, s57, s56
    buffer_load_dwordx4 v[96:99], v4, s[28:31], s56 offen sc1
    s_waitcnt vmcnt(25)
    v_mfma_f32_32x32x16_bf16 v[48:63], a[180:183], v[100:103], v[48:63]
    v_mfma_f32_32x32x16_bf16 v[80:95], a[184:187], v[100:103], v[80:95]
    buffer_load_dwordx4 v[100:103], v5, s[28:31], s56 offen sc1
    s_waitcnt vmcnt(19)
    s_lshl_b32 s50, s36, 8
    s_lshr_b32 s51, s38, 1
    s_lshl_b32 s51, s51, 7
    s_add_u32 s50, s50, s51
    s_lshl_b32 s51, s37, 3
    s_add_u32 s50, s50, s51
    s_and_b32 s51, s38, 1
    s_lshl_b32 s51, s51, 2
    s_add_u32 s50, s50, s51
    s_add_u32 s50, s50, 57344
    v_mov_b32 v2, s50
    v_mov_b32 v3, s75
    s_mov_b64 exec, 1
    buffer_store_dword v3, v2, s[60:63], 0 offen sc1
    s_mov_b64 exec, -1
    v_mfma_f32_32x32x16_bf16 v[32:47], a[188:191], v[104:107], v[32:47]
    v_mfma_f32_32x32x16_bf16 v[64:79], a[192:195], v[104:107], v[64:79]
    s_add_u32 s56, s56, 1024
    s_cmp_eq_u32 s56, s46
    s_cselect_b32 s56, s57, s56
    buffer_load_dwordx4 v[104:107], v4, s[28:31], s56 offen sc1
    v_mfma_f32_32x32x16_bf16 v[48:63], a[188:191], v[108:111], v[48:63]
    v_mfma_f32_32x32x16_bf16 v[80:95], a[192:195], v[108:111], v[80:95]
    buffer_load_dwordx4 v[108:111], v5, s[28:31], s56 offen sc1
    v_mfma_f32_32x32x16_bf16 v[32:47], a[196:199], v[112:115], v[32:47]
    s_waitcnt vmcnt(16)
    v_mfma_f32_16x16x32_bf16 v[184:187], v[200:203], v[144:147], 0
    s_waitcnt vmcnt(15)
    v_mfma_f32_16x16x32_bf16 v[184:187], v[200:203], v[148:151], v[184:187]
    s_waitcnt vmcnt(14)
    v_mfma_f32_16x16x32_bf16 v[184:187], v[200:203], v[152:155], v[184:187]
    v_mfma_f32_32x32x16_bf16 v[64:79], a[200:203], v[112:115], v[64:79]
    s_add_u32 s56, s56, 1024
    s_cmp_eq_u32 s56, s46
    s_cselect_b32 s56, s57, s56
    buffer_load_dwordx4 v[112:115], v4, s[28:31], s56 offen sc1
    s_waitcnt vmcnt(14)
    v_mfma_f32_16x16x32_bf16 v[184:187], v[200:203], v[156:159], v[184:187]
    s_waitcnt vmcnt(13)
    v_mfma_f32_16x16x32_bf16 v[184:187], v[200:203], v[160:163], v[184:187]
    s_waitcnt vmcnt(9)
    v_mfma_f32_16x16x32_bf16 v[184:187], v[200:203], v[164:167], v[184:187]
    v_mfma_f32_32x32x16_bf16 v[48:63], a[196:199], v[116:119], v[48:63]
    s_waitcnt vmcnt(8)
    v_mfma_f32_16x16x32_bf16 v[184:187], v[200:203], v[168:171], v[184:187]
    s_waitcnt vmcnt(6)
    v_mfma_f32_16x16x32_bf16 v[184:187], v[200:203], v[172:175], v[184:187]
    s_nop 7
    v_cvt_pk_bf16_f32 v188, v184, v185
    v_mfma_f32_32x32x16_bf16 v[80:95], a[200:203], v[116:119], v[80:95]
    buffer_load_dwordx4 v[116:119], v5, s[28:31], s56 offen sc1
    v_cvt_pk_bf16_f32 v189, v186, v187
    s_lshr_b32 s48, s38, 1
    s_lshl_b32 s48, s48, 10
    s_and_b32 s49, s38, 1
    s_lshl_b32 s49, s49, 3
    s_add_u32 s48, s48, s49
    s_add_u32 s48, s48, 137728
    v_add_u32 v2, s48, v15
    ds_write_b64 v2, v[188:189]
    v_mfma_f32_32x32x16_bf16 v[32:47], a[204:207], v[120:123], v[32:47]
    s_waitcnt lgkmcnt(0)
    s_barrier
    v_add_u32 v2, 137728, v15
    ds_read_b128 v[248:251], v2 offset:0
    ds_read_b128 v[252:255], v2 offset:1024
    v_mfma_f32_32x32x16_bf16 v[64:79], a[208:211], v[120:123], v[64:79]
    s_add_u32 s56, s56, 1024
    s_cmp_eq_u32 s56, s46
    s_cselect_b32 s56, s57, s56
    buffer_load_dwordx4 v[120:123], v4, s[28:31], s56 offen sc1
    v_mfma_f32_32x32x16_bf16 v[48:63], a[204:207], v[124:127], v[48:63]
    s_waitcnt lgkmcnt(1)
    v_mfma_f32_32x32x16_bf16 v[204:219], v[248:251], v[176:179], 0
    v_mfma_f32_32x32x16_bf16 v[80:95], a[208:211], v[124:127], v[80:95]
    buffer_load_dwordx4 v[124:127], v5, s[28:31], s56 offen sc1
    s_waitcnt lgkmcnt(0)
    v_mfma_f32_32x32x16_bf16 v[204:219], v[252:255], v[180:183], v[204:219]
    v_mfma_f32_32x32x16_bf16 v[32:47], a[212:215], v[128:131], v[32:47]
    v_mfma_f32_32x32x16_bf16 v[64:79], a[216:219], v[128:131], v[64:79]
    s_add_u32 s56, s56, 1024
    s_cmp_eq_u32 s56, s46
    s_cselect_b32 s56, s57, s56
    buffer_load_dwordx4 v[128:131], v4, s[28:31], s56 offen sc1
    s_nop 5
    v_mov_b32 v184, v216
    v_mov_b32 v185, v216
    s_nop 1
    v_permlane32_swap_b32 v184, v185
    v_add_f32 v184, 0x358637bd, v185
    v_rcp_f32 v184, v184
    v_mfma_f32_32x32x16_bf16 v[48:63], a[212:215], v[132:135], v[48:63]
    v_mul_f32 v204, v204, v184
    v_mul_f32 v205, v205, v184
    v_cvt_pk_bf16_f32 v204, v204, v205
    v_mul_f32 v206, v206, v184
    v_mul_f32 v207, v207, v184
    v_mfma_f32_32x32x16_bf16 v[80:95], a[216:219], v[132:135], v[80:95]
    buffer_load_dwordx4 v[132:135], v5, s[28:31], s56 offen sc1
    v_cvt_pk_bf16_f32 v205, v206, v207
    v_mul_f32 v208, v208, v184
    v_mul_f32 v209, v209, v184
    v_cvt_pk_bf16_f32 v206, v208, v209
    v_mfma_f32_32x32x16_bf16 v[32:47], a[220:223], v[136:139], v[32:47]
    v_mul_f32 v210, v210, v184
    v_mul_f32 v211, v211, v184
    v_cvt_pk_bf16_f32 v207, v210, v211
    v_mul_f32 v212, v212, v184
    v_mul_f32 v213, v213, v184
    v_mfma_f32_32x32x16_bf16 v[64:79], a[224:227], v[136:139], v[64:79]
    s_add_u32 s56, s56, 1024
    s_cmp_eq_u32 s56, s46
    s_cselect_b32 s56, s57, s56
    buffer_load_dwordx4 v[136:139], v4, s[28:31], s56 offen sc1
    v_cvt_pk_bf16_f32 v208, v212, v213
    v_mul_f32 v214, v214, v184
    v_mul_f32 v215, v215, v184
    v_cvt_pk_bf16_f32 v209, v214, v215
    v_mfma_f32_32x32x16_bf16 v[48:63], a[220:223], v[140:143], v[48:63]
    v_mul_f32 v216, v216, v184
    v_mul_f32 v217, v217, v184
    v_cvt_pk_bf16_f32 v210, v216, v217
    v_mul_f32 v218, v218, v184
    v_mul_f32 v219, v219, v184
    v_mfma_f32_32x32x16_bf16 v[80:95], a[224:227], v[140:143], v[80:95]
    buffer_load_dwordx4 v[140:143], v5, s[28:31], s56 offen sc1
    v_cvt_pk_bf16_f32 v211, v218, v219
    v_cndmask_b32 v210, 0, v210, s[54:55]
    v_cndmask_b32 v211, 0, v211, s[54:55]
    s_lshl_b32 s50, s36, 2
    s_add_u32 s50, s50, s38
    s_mul_i32 s50, s50, 144
    s_lshl_b32 s51, s37, 1
    s_add_u32 s50, s50, s51
    s_add_u32 s50, s50, 112
    s_lshl_b32 s50, s50, 10
    buffer_store_dwordx4 v[204:207], v15, s[28:31], s50 offen offset:0 sc1
    buffer_store_dwordx4 v[208:211], v15, s[28:31], s50 offen offset:1024 sc1
    v_mfma_f32_32x32x16_bf16 v[32:47], a[228:231], v[192:195], v[32:47]
    s_add_u32 s71, s71, 2048
    s_cmp_eq_u32 s71, s82
    s_cselect_b32 s71, s70, s71
    buffer_load_dwordx4 a[112:115], v21, s[76:79], s71 offen sc1
    v_mfma_f32_32x32x16_bf16 v[64:79], a[232:235], v[192:195], v[64:79]
    buffer_load_dwordx4 a[116:119], v28, s[76:79], s71 offen sc1
    v_mfma_f32_32x32x16_bf16 v[48:63], a[228:231], v[196:199], v[48:63]
    v_mfma_f32_32x32x16_bf16 v[80:95], a[232:235], v[196:199], v[80:95]
    v_and_b32 v7, 7, v1
    v_lshlrev_b32 v7, 2, v7
    s_lshl_b32 s48, s14, 7
    s_lshl_b32 s49, s38, 5
    s_add_u32 s48, s48, s49
    s_add_u32 s48, s48, 57344
    v_add_u32 v7, s48, v7
    buffer_load_dword v7, v7, s[60:63], 0 offen sc1
    v_mfma_f32_32x32x16_bf16 v[32:47], a[236:239], v[228:231], v[32:47]
    s_add_u32 s71, s71, 2048
    s_cmp_eq_u32 s71, s82
    s_cselect_b32 s71, s70, s71
    buffer_load_dwordx4 a[120:123], v21, s[76:79], s71 offen sc1
    v_mfma_f32_32x32x16_bf16 v[64:79], a[240:243], v[228:231], v[64:79]
    buffer_load_dwordx4 a[124:127], v28, s[76:79], s71 offen sc1
    v_mfma_f32_32x32x16_bf16 v[48:63], a[236:239], v[232:235], v[48:63]
    v_mfma_f32_32x32x16_bf16 v[80:95], a[240:243], v[232:235], v[80:95]
    s_waitcnt vmcnt(19)
    v_mfma_f32_32x32x16_bf16 v[32:47], a[244:247], v[96:99], v[32:47]
    s_add_u32 s71, s71, 2048
    s_cmp_eq_u32 s71, s82
    s_cselect_b32 s71, s70, s71
    buffer_load_dwordx4 a[128:131], v21, s[76:79], s71 offen sc1
    v_mfma_f32_32x32x16_bf16 v[64:79], a[248:251], v[96:99], v[64:79]
    buffer_load_dwordx4 a[132:135], v28, s[76:79], s71 offen sc1
    s_waitcnt vmcnt(20)
    v_mfma_f32_32x32x16_bf16 v[48:63], a[244:247], v[100:103], v[48:63]
    v_mfma_f32_32x32x16_bf16 v[80:95], a[248:251], v[100:103], v[80:95]
    s_waitcnt vmcnt(18)
    v_mfma_f32_32x32x16_bf16 v[32:47], a[0:3], v[104:107], v[32:47]
    buffer_load_dwordx4 a[136:139], v21, s[76:79], s83 offen sc1
    v_mfma_f32_32x32x16_bf16 v[64:79], a[4:7], v[104:107], v[64:79]
    buffer_load_dwordx4 a[140:143], v28, s[76:79], s83 offen sc1
    s_waitcnt vmcnt(19)
    v_mfma_f32_32x32x16_bf16 v[48:63], a[0:3], v[108:111], v[48:63]
    v_mfma_f32_32x32x16_bf16 v[80:95], a[4:7], v[108:111], v[80:95]
    s_waitcnt vmcnt(9)
    s_lshl_b32 s50, s36, 8
    s_lshr_b32 s51, s38, 1
    s_lshl_b32 s51, s51, 7
    s_add_u32 s50, s50, s51
    s_lshl_b32 s51, s37, 3
    s_add_u32 s50, s50, s51
    s_and_b32 s51, s38, 1
    s_lshl_b32 s51, s51, 2
    s_add_u32 s50, s50, s51
    s_add_u32 s50, s50, 4096
    v_mov_b32 v2, s50
    v_mov_b32 v3, s75
    s_mov_b64 exec, 1
    buffer_store_dword v3, v2, s[60:63], 0 offen sc1
    s_mov_b64 exec, -1
    v_mfma_f32_32x32x16_bf16 v[32:47], a[8:11], v[112:115], v[32:47]
    s_add_u32 s83, s83, 2048
    buffer_load_dwordx4 a[144:147], v21, s[76:79], s83 offen sc1
    v_mfma_f32_32x32x16_bf16 v[64:79], a[12:15], v[112:115], v[64:79]
    buffer_load_dwordx4 a[148:151], v28, s[76:79], s83 offen sc1
    v_mfma_f32_32x32x16_bf16 v[48:63], a[8:11], v[116:119], v[48:63]
    v_mfma_f32_32x32x16_bf16 v[80:95], a[12:15], v[116:119], v[80:95]
    v_mfma_f32_32x32x16_bf16 v[32:47], a[16:19], v[120:123], v[32:47]
    s_add_u32 s83, s83, 2048
    buffer_load_dwordx4 a[152:155], v21, s[76:79], s83 offen sc1
    v_mfma_f32_32x32x16_bf16 v[64:79], a[20:23], v[120:123], v[64:79]
    buffer_load_dwordx4 a[156:159], v28, s[76:79], s83 offen sc1
    v_mfma_f32_32x32x16_bf16 v[48:63], a[16:19], v[124:127], v[48:63]
    v_mfma_f32_32x32x16_bf16 v[80:95], a[20:23], v[124:127], v[80:95]
    v_mfma_f32_32x32x16_bf16 v[32:47], a[24:27], v[128:131], v[32:47]
    s_waitcnt vmcnt(11)
    v_cmp_ne_u32 vcc, s75, v7
    s_nop 0
    s_cbranch_vccnz L_slowA2_14
L_okA2_15:
    s_add_u32 s83, s83, 2048
    buffer_load_dwordx4 a[160:163], v21, s[76:79], s83 offen sc1
    v_mfma_f32_32x32x16_bf16 v[64:79], a[28:31], v[128:131], v[64:79]
    buffer_load_dwordx4 a[252:255], v28, s[76:79], s83 offen sc1
    s_mov_b32 s56, s74
    buffer_load_dwordx4 v[192:195], v4, s[28:31], s56 offen sc1
    buffer_load_dwordx4 v[196:199], v5, s[28:31], s56 offen sc1
    s_add_u32 s56, s56, 1024
    s_cmp_eq_u32 s56, s58
    s_cselect_b32 s56, s46, s56
    buffer_load_dwordx4 v[228:231], v4, s[28:31], s56 offen sc1
    buffer_load_dwordx4 v[232:235], v5, s[28:31], s56 offen sc1
    v_mfma_f32_32x32x16_bf16 v[48:63], a[24:27], v[132:135], v[48:63]
    v_mfma_f32_32x32x16_bf16 v[80:95], a[28:31], v[132:135], v[80:95]
    v_mfma_f32_32x32x16_bf16 v[32:47], a[32:35], v[136:139], v[32:47]
    s_add_u32 s83, s83, 2048
    buffer_load_dwordx4 v[144:147], v21, s[76:79], s83 offen sc1
    v_mfma_f32_32x32x16_bf16 v[64:79], a[36:39], v[136:139], v[64:79]
    buffer_load_dwordx4 v[148:151], v28, s[76:79], s83 offen sc1
    s_add_u32 s56, s56, 1024
    s_cmp_eq_u32 s56, s58
    s_cselect_b32 s56, s46, s56
    buffer_load_dwordx4 v[96:99], v4, s[28:31], s56 offen sc1
    buffer_load_dwordx4 v[100:103], v5, s[28:31], s56 offen sc1
    s_add_u32 s56, s56, 1024
    s_cmp_eq_u32 s56, s58
    s_cselect_b32 s56, s46, s56
    buffer_load_dwordx4 v[104:107], v4, s[28:31], s56 offen sc1
    buffer_load_dwordx4 v[108:111], v5, s[28:31], s56 offen sc1
    v_mfma_f32_32x32x16_bf16 v[48:63], a[32:35], v[140:143], v[48:63]
    v_mfma_f32_32x32x16_bf16 v[80:95], a[36:39], v[140:143], v[80:95]
    s_waitcnt vmcnt(9)
    v_mfma_f32_32x32x16_bf16 v[32:47], a[40:43], v[192:195], v[32:47]
    s_add_u32 s83, s83, 2048
    buffer_load_dwordx4 v[152:155], v21, s[76:79], s83 offen sc1
    v_mfma_f32_32x32x16_bf16 v[64:79], a[44:47], v[192:195], v[64:79]
    buffer_load_dwordx4 v[156:159], v28, s[76:79], s83 offen sc1
    s_add_u32 s56, s56, 1024
    s_cmp_eq_u32 s56, s58
    s_cselect_b32 s56, s46, s56
    buffer_load_dwordx4 v[112:115], v4, s[28:31], s56 offen sc1
    buffer_load_dwordx4 v[116:119], v5, s[28:31], s56 offen sc1
    s_add_u32 s56, s56, 1024
    s_cmp_eq_u32 s56, s58
    s_cselect_b32 s56, s46, s56
    buffer_load_dwordx4 v[120:123], v4, s[28:31], s56 offen sc1
    buffer_load_dwordx4 v[124:127], v5, s[28:31], s56 offen sc1
    s_waitcnt vmcnt(14)
    v_mfma_f32_32x32x16_bf16 v[48:63], a[40:43], v[196:199], v[48:63]
    v_mfma_f32_32x32x16_bf16 v[80:95], a[44:47], v[196:199], v[80:95]
    s_waitcnt vmcnt(13)
    v_mfma_f32_32x32x16_bf16 v[32:47], a[48:51], v[228:231], v[32:47]
    s_add_u32 s83, s83, 2048
    buffer_load_dwordx4 v[160:163], v21, s[76:79], s83 offen sc1
    v_mfma_f32_32x32x16_bf16 v[64:79], a[52:55], v[228:231], v[64:79]
    buffer_load_dwordx4 v[164:167], v28, s[76:79], s83 offen sc1
    s_add_u32 s56, s56, 1024
    s_cmp_eq_u32 s56, s58
    s_cselect_b32 s56, s46, s56
    buffer_load_dwordx4 v[128:131], v4, s[28:31], s56 offen sc1
    buffer_load_dwordx4 v[132:135], v5, s[28:31], s56 offen sc1
    s_add_u32 s56, s56, 1024
    s_cmp_eq_u32 s56, s58
    s_cselect_b32 s56, s46, s56
    buffer_load_dwordx4 v[136:139], v4, s[28:31], s56 offen sc1
    buffer_load_dwordx4 v[140:143], v5, s[28:31], s56 offen sc1
    s_waitcnt vmcnt(18)
    v_mfma_f32_32x32x16_bf16 v[48:63], a[48:51], v[232:235], v[48:63]
    v_mfma_f32_32x32x16_bf16 v[80:95], a[52:55], v[232:235], v[80:95]
    s_waitcnt vmcnt(15)
    v_mfma_f32_32x32x16_bf16 v[32:47], a[56:59], v[96:99], v[32:47]
    s_add_u32 s83, s83, 2048
    buffer_load_dwordx4 v[168:171], v21, s[76:79], s83 offen sc1
    v_mfma_f32_32x32x16_bf16 v[64:79], a[60:63], v[96:99], v[64:79]
    buffer_load_dwordx4 v[172:175], v28, s[76:79], s83 offen sc1
    s_add_u32 s56, s56, 1024
    s_cmp_eq_u32 s56, s58
    s_cselect_b32 s56, s46, s56
    buffer_load_dwordx4 v[192:195], v4, s[28:31], s56 offen sc1
    buffer_load_dwordx4 v[196:199], v5, s[28:31], s56 offen sc1
    s_add_u32 s56, s56, 1024
    s_cmp_eq_u32 s56, s58
    s_cselect_b32 s56, s46, s56
    buffer_load_dwordx4 v[228:231], v4, s[28:31], s56 offen sc1
    buffer_load_dwordx4 v[232:235], v5, s[28:31], s56 offen sc1
    s_waitcnt vmcnt(20)
    v_mfma_f32_32x32x16_bf16 v[48:63], a[56:59], v[100:103], v[48:63]
    v_mfma_f32_32x32x16_bf16 v[80:95], a[60:63], v[100:103], v[80:95]
    s_waitcnt vmcnt(19)
    v_mfma_f32_32x32x16_bf16 v[32:47], a[64:67], v[104:107], v[32:47]
    v_mfma_f32_32x32x16_bf16 v[64:79], a[68:71], v[104:107], v[64:79]
    s_add_u32 s56, s56, 1024
    s_cmp_eq_u32 s56, s58
    s_cselect_b32 s56, s46, s56
    buffer_load_dwordx4 v[96:99], v4, s[28:31], s56 offen sc1
    buffer_load_dwordx4 v[100:103], v5, s[28:31], s56 offen sc1
    s_add_u32 s56, s56, 1024
    s_cmp_eq_u32 s56, s58
    s_cselect_b32 s56, s46, s56
    buffer_load_dwordx4 v[104:107], v4, s[28:31], s56 offen sc1
    s_waitcnt vmcnt(21)
    v_mfma_f32_32x32x16_bf16 v[48:63], a[64:67], v[108:111], v[48:63]
    v_mfma_f32_32x32x16_bf16 v[80:95], a[68:71], v[108:111], v[80:95]
    buffer_load_dwordx4 v[108:111], v5, s[28:31], s56 offen sc1
    v_and_b32 v6, 7, v1
    v_lshlrev_b32 v6, 2, v6
    s_lshl_b32 s48, s14, 7
    s_lshl_b32 s49, s38, 5
    s_add_u32 s48, s48, s49
    s_add_u32 s48, s48, 4096
    v_add_u32 v6, s48, v6
    buffer_load_dword v6, v6, s[60:63], 0 offen sc1
    s_waitcnt vmcnt(20)
    v_mfma_f32_32x32x16_bf16 v[32:47], a[72:75], v[112:115], v[32:47]
    v_mfma_f32_32x32x16_bf16 v[64:79], a[76:79], v[112:115], v[64:79]
    s_waitcnt vmcnt(19)
    v_mfma_f32_32x32x16_bf16 v[48:63], a[72:75], v[116:119], v[48:63]
    v_mfma_f32_32x32x16_bf16 v[80:95], a[76:79], v[116:119], v[80:95]
    s_waitcnt vmcnt(18)
    v_mfma_f32_32x32x16_bf16 v[32:47], a[80:83], v[120:123], v[32:47]
    v_mfma_f32_32x32x16_bf16 v[64:79], a[84:87], v[120:123], v[64:79]
    s_waitcnt vmcnt(17)
    v_mfma_f32_32x32x16_bf16 v[48:63], a[80:83], v[124:127], v[48:63]
    v_mfma_f32_32x32x16_bf16 v[80:95], a[84:87], v[124:127], v[80:95]
    s_waitcnt vmcnt(14)
    v_mfma_f32_32x32x16_bf16 v[32:47], a[88:91], v[128:131], v[32:47]
    v_mfma_f32_32x32x16_bf16 v[64:79], a[92:95], v[128:131], v[64:79]
    s_waitcnt vmcnt(13)
    v_mfma_f32_32x32x16_bf16 v[48:63], a[88:91], v[132:135], v[48:63]
    v_mfma_f32_32x32x16_bf16 v[80:95], a[92:95], v[132:135], v[80:95]
    s_waitcnt vmcnt(12)
    v_mfma_f32_32x32x16_bf16 v[32:47], a[96:99], v[136:139], v[32:47]
    v_mfma_f32_32x32x16_bf16 v[64:79], a[100:103], v[136:139], v[64:79]
    s_waitcnt vmcnt(11)
    v_mfma_f32_32x32x16_bf16 v[48:63], a[96:99], v[140:143], v[48:63]
    v_mfma_f32_32x32x16_bf16 v[80:95], a[100:103], v[140:143], v[80:95]
    s_waitcnt vmcnt(8)
    v_mfma_f32_32x32x16_bf16 v[32:47], a[104:107], v[192:195], v[32:47]
    v_mfma_f32_32x32x16_bf16 v[64:79], a[108:111], v[192:195], v[64:79]
    s_waitcnt vmcnt(7)
    v_mfma_f32_32x32x16_bf16 v[48:63], a[104:107], v[196:199], v[48:63]
    v_mfma_f32_32x32x16_bf16 v[80:95], a[108:111], v[196:199], v[80:95]
    s_waitcnt vmcnt(6)
    v_mfma_f32_32x32x16_bf16 v[32:47], a[112:115], v[228:231], v[32:47]
    s_waitcnt vmcnt(0)
    v_cmp_ne_u32 vcc, s75, v6
    s_nop 0
    s_cbranch_vccnz L_slowO_16
L_okO_17:
    v_mfma_f32_32x32x16_bf16 v[64:79], a[116:119], v[228:231], v[64:79]
    s_mov_b32 s56, s59
    buffer_load_dwordx4 v[112:115], v4, s[28:31], s56 offen sc1
    buffer_load_dwordx4 v[116:119], v5, s[28:31], s56 offen sc1
    s_add_u32 s56, s56, 1024
    buffer_load_dwordx4 v[120:123], v4, s[28:31], s56 offen sc1
    buffer_load_dwordx4 v[124:127], v5, s[28:31], s56 offen sc1
    v_mfma_f32_32x32x16_bf16 v[48:63], a[112:115], v[232:235], v[48:63]
    v_mfma_f32_32x32x16_bf16 v[80:95], a[116:119], v[232:235], v[80:95]
    v_mfma_f32_32x32x16_bf16 v[32:47], a[120:123], v[96:99], v[32:47]
    v_mfma_f32_32x32x16_bf16 v[64:79], a[124:127], v[96:99], v[64:79]
    s_add_u32 s56, s56, 1024
    buffer_load_dwordx4 v[128:131], v4, s[28:31], s56 offen sc1
    buffer_load_dwordx4 v[132:135], v5, s[28:31], s56 offen sc1
    s_add_u32 s56, s56, 1024
    buffer_load_dwordx4 v[136:139], v4, s[28:31], s56 offen sc1
    buffer_load_dwordx4 v[140:143], v5, s[28:31], s56 offen sc1
    v_mfma_f32_32x32x16_bf16 v[48:63], a[120:123], v[100:103], v[48:63]
    v_mfma_f32_32x32x16_bf16 v[80:95], a[124:127], v[100:103], v[80:95]
    v_mfma_f32_32x32x16_bf16 v[32:47], a[128:131], v[104:107], v[32:47]
    s_mov_b32 s40, s100
    s_mov_b32 s41, s101
    s_and_b32 s41, s41, 0xffff
    s_mov_b32 s42, 0x1c0000
    s_mov_b32 s43, 0x20000
    v_lshrrev_b32 v14, 3, v1
    v_mfma_f32_32x32x16_bf16 v[64:79], a[132:135], v[104:107], v[64:79]
    s_add_u32 s56, s56, 1024
    buffer_load_dwordx4 v[192:195], v4, s[28:31], s56 offen sc1
    buffer_load_dwordx4 v[196:199], v5, s[28:31], s56 offen sc1
    s_add_u32 s56, s56, 1024
    buffer_load_dwordx4 v[228:231], v4, s[28:31], s56 offen sc1
    buffer_load_dwordx4 v[232:235], v5, s[28:31], s56 offen sc1
    v_mul_u32_u24 v14, 896, v14
    v_and_b32 v236, 7, v1
    v_mfma_f32_32x32x16_bf16 v[48:63], a[128:131], v[108:111], v[48:63]
    v_lshl_add_u32 v14, v236, 4, v14
    v_mfma_f32_32x32x16_bf16 v[80:95], a[132:135], v[108:111], v[80:95]
    s_lshl_b32 s48, s14, 2
    s_add_u32 s48, s48, s38
    s_mul_i32 s48, s48, 14336
    s_lshl_b32 s49, s15, 7
    s_add_u32 s48, s48, s49
    v_add_u32 v14, s48, v14
    v_and_b32 v236, 1, v1
    s_waitcnt vmcnt(11)
    v_mfma_f32_32x32x16_bf16 v[32:47], a[136:139], v[112:115], v[32:47]
    v_lshrrev_b32 v237, 5, v1
    v_mfma_f32_32x32x16_bf16 v[64:79], a[140:143], v[112:115], v[64:79]
    s_add_u32 s56, s56, 1024
    buffer_load_dwordx4 v[96:99], v4, s[28:31], s56 offen sc1
    buffer_load_dwordx4 v[100:103], v5, s[28:31], s56 offen sc1
    s_add_u32 s56, s56, 1024
    buffer_load_dwordx4 v[104:107], v4, s[28:31], s56 offen sc1
    buffer_load_dwordx4 v[108:111], v5, s[28:31], s56 offen sc1
    v_xor_b32 v236, v236, v237
    v_lshlrev_b32 v236, 3, v236
    s_waitcnt vmcnt(14)
    v_mfma_f32_32x32x16_bf16 v[48:63], a[136:139], v[116:119], v[48:63]
    v_and_b32 v237, 7, v1
    v_mfma_f32_32x32x16_bf16 v[80:95], a[140:143], v[116:119], v[80:95]
    v_or_b32 v236, v236, v237
    v_lshlrev_b32 v236, 4, v236
    s_waitcnt vmcnt(13)
    v_mfma_f32_32x32x16_bf16 v[32:47], a[144:147], v[120:123], v[32:47]
    v_and_b32 v237, 31, v1
    v_mfma_f32_32x32x16_bf16 v[64:79], a[148:151], v[120:123], v[64:79]
    v_lshl_add_u32 v236, v237, 8, v236
    s_lshl_b32 s48, s38, 14
    v_add_u32 v248, s48, v236
    s_waitcnt vmcnt(12)
    v_mfma_f32_32x32x16_bf16 v[48:63], a[144:147], v[124:127], v[48:63]
    v_xor_b32 v249, 16, v248
    v_mfma_f32_32x32x16_bf16 v[80:95], a[148:151], v[124:127], v[80:95]
    v_xor_b32 v250, 32, v248
    v_xor_b32 v251, 48, v248
    s_waitcnt vmcnt(11)
    v_mfma_f32_32x32x16_bf16 v[32:47], a[152:155], v[128:131], v[32:47]
    v_xor_b32 v252, 64, v248
    v_mfma_f32_32x32x16_bf16 v[64:79], a[156:159], v[128:131], v[64:79]
    v_xor_b32 v253, 80, v248
    v_xor_b32 v254, 96, v248
    s_waitcnt vmcnt(10)
    v_mfma_f32_32x32x16_bf16 v[48:63], a[152:155], v[132:135], v[48:63]
    v_xor_b32 v255, 112, v248
    v_mfma_f32_32x32x16_bf16 v[80:95], a[156:159], v[132:135], v[80:95]
    v_bfe_u32 v236, v1, 3, 1
    v_lshlrev_b32 v236, 3, v236
    s_waitcnt vmcnt(9)
    v_mfma_f32_32x32x16_bf16 v[32:47], a[160:163], v[136:139], v[32:47]
    v_lshrrev_b32 v237, 3, v1
    v_or_b32 v236, v236, v237
    v_mfma_f32_32x32x16_bf16 v[64:79], a[252:255], v[136:139], v[64:79]
    v_and_b32 v220, 7, v1
    s_waitcnt vmcnt(8)
    v_mfma_f32_32x32x16_bf16 v[48:63], a[160:163], v[140:143], v[48:63]
    v_xor_b32 v236, v236, v220
    v_lshlrev_b32 v236, 4, v236
    v_mfma_f32_32x32x16_bf16 v[80:95], a[252:255], v[140:143], v[80:95]
    v_lshl_add_u32 v236, v237, 8, v236
    s_waitcnt vmcnt(7)
    v_mfma_f32_32x32x16_bf16 v[32:47], v[144:147], v[192:195], v[32:47]
    s_lshl_b32 s48, s38, 12
    v_add_u32 v220, s48, v236
    v_xor_b32 v221, 128, v220
    v_mfma_f32_32x32x16_bf16 v[64:79], v[148:151], v[192:195], v[64:79]
    v_lshlrev_b32 v204, 16, v240
    s_waitcnt vmcnt(6)
    v_mfma_f32_32x32x16_bf16 v[48:63], v[144:147], v[196:199], v[48:63]
    v_and_b32 v205, 0xffff0000, v240
    v_lshlrev_b32 v206, 16, v241
    v_mfma_f32_32x32x16_bf16 v[80:95], v[148:151], v[196:199], v[80:95]
    v_and_b32 v207, 0xffff0000, v241
    s_waitcnt vmcnt(5)
    v_mfma_f32_32x32x16_bf16 v[32:47], v[152:155], v[228:231], v[32:47]
    v_lshlrev_b32 v208, 16, v242
    v_and_b32 v209, 0xffff0000, v242
    v_mfma_f32_32x32x16_bf16 v[64:79], v[156:159], v[228:231], v[64:79]
    v_lshlrev_b32 v210, 16, v243
    s_waitcnt vmcnt(4)
    v_mfma_f32_32x32x16_bf16 v[48:63], v[152:155], v[232:235], v[48:63]
    v_and_b32 v211, 0xffff0000, v243
    v_lshlrev_b32 v212, 16, v244
    v_mfma_f32_32x32x16_bf16 v[80:95], v[156:159], v[232:235], v[80:95]
    v_and_b32 v213, 0xffff0000, v244
    s_waitcnt vmcnt(3)
    v_mfma_f32_32x32x16_bf16 v[32:47], v[160:163], v[96:99], v[32:47]
    v_lshlrev_b32 v214, 16, v245
    v_and_b32 v215, 0xffff0000, v245
    v_mfma_f32_32x32x16_bf16 v[64:79], v[164:167], v[96:99], v[64:79]
    v_lshlrev_b32 v216, 16, v246
    s_waitcnt vmcnt(2)
    v_mfma_f32_32x32x16_bf16 v[48:63], v[160:163], v[100:103], v[48:63]
    v_and_b32 v217, 0xffff0000, v246
    v_lshlrev_b32 v218, 16, v247
    v_mfma_f32_32x32x16_bf16 v[80:95], v[164:167], v[100:103], v[80:95]
    v_and_b32 v219, 0xffff0000, v247
    s_waitcnt vmcnt(1)
    v_mfma_f32_32x32x16_bf16 v[32:47], v[168:171], v[104:107], v[32:47]
    v_mfma_f32_32x32x16_bf16 v[64:79], v[172:175], v[104:107], v[64:79]
    s_waitcnt vmcnt(0)
    v_mfma_f32_32x32x16_bf16 v[48:63], v[168:171], v[108:111], v[48:63]
    v_mfma_f32_32x32x16_bf16 v[80:95], v[172:175], v[108:111], v[80:95]
    s_nop 7
    ds_write_b128 v248, v[32:35] offset:0
    ds_write_b128 v249, v[36:39] offset:0
    ds_write_b128 v250, v[40:43] offset:0
    ds_write_b128 v251, v[44:47] offset:0
    ds_write_b128 v252, v[64:67] offset:0
    ds_write_b128 v253, v[68:71] offset:0
    ds_write_b128 v254, v[72:75] offset:0
    ds_write_b128 v255, v[76:79] offset:0
    ds_write_b128 v248, v[48:51] offset:8192
    ds_write_b128 v249, v[52:55] offset:8192
    ds_write_b128 v250, v[56:59] offset:8192
    ds_write_b128 v251, v[60:63] offset:8192
    ds_write_b128 v252, v[80:83] offset:8192
    ds_write_b128 v253, v[84:87] offset:8192
    ds_write_b128 v254, v[88:91] offset:8192
    ds_write_b128 v255, v[92:95] offset:8192
    s_waitcnt lgkmcnt(0)
    s_barrier
    ds_read_b128 v[96:99], v220 offset:0
    ds_read_b128 v[100:103], v221 offset:0
    ds_read_b128 v[104:107], v220 offset:16384
    ds_read_b128 v[108:111], v221 offset:16384
    ds_read_b128 v[112:115], v220 offset:32768
    ds_read_b128 v[116:119], v221 offset:32768
    ds_read_b128 v[120:123], v220 offset:49152
    ds_read_b128 v[124:127], v221 offset:49152
    ds_read_b128 v[128:131], v220 offset:2048
    ds_read_b128 v[132:135], v221 offset:2048
    ds_read_b128 v[136:139], v220 offset:18432
    ds_read_b128 v[140:143], v221 offset:18432
    ds_read_b128 v[144:147], v220 offset:34816
    ds_read_b128 v[148:151], v221 offset:34816
    ds_read_b128 v[152:155], v220 offset:51200
    ds_read_b128 v[156:159], v221 offset:51200
    s_movk_i32 s48, 7168
    s_waitcnt lgkmcnt(12)
    v_pk_add_f32 v[96:97], v[96:97], v[204:205]
    v_pk_add_f32 v[98:99], v[98:99], v[206:207]
    v_pk_add_f32 v[100:101], v[100:101], v[208:209]
    v_pk_add_f32 v[102:103], v[102:103], v[210:211]
    v_pk_add_f32 v[96:97], v[96:97], v[104:105]
    v_pk_add_f32 v[98:99], v[98:99], v[106:107]
    v_pk_add_f32 v[100:101], v[100:101], v[108:109]
    v_pk_add_f32 v[102:103], v[102:103], v[110:111]
    s_waitcnt lgkmcnt(8)
    v_pk_add_f32 v[112:113], v[112:113], v[120:121]
    v_pk_add_f32 v[114:115], v[114:115], v[122:123]
    v_pk_add_f32 v[116:117], v[116:117], v[124:125]
    v_pk_add_f32 v[118:119], v[118:119], v[126:127]
    v_pk_add_f32 v[96:97], v[96:97], v[112:113]
    v_pk_add_f32 v[98:99], v[98:99], v[114:115]
    v_pk_add_f32 v[100:101], v[100:101], v[116:117]
    v_pk_add_f32 v[102:103], v[102:103], v[118:119]
    v_cvt_pk_bf16_f32 v240, v96, v97
    v_cvt_pk_bf16_f32 v241, v98, v99
    v_cvt_pk_bf16_f32 v242, v100, v101
    v_cvt_pk_bf16_f32 v243, v102, v103
    buffer_store_dwordx4 v[240:243], v14, s[40:43], 0 offen
    s_waitcnt lgkmcnt(4)
    v_pk_add_f32 v[128:129], v[128:129], v[212:213]
    v_pk_add_f32 v[130:131], v[130:131], v[214:215]
    v_pk_add_f32 v[132:133], v[132:133], v[216:217]
    v_pk_add_f32 v[134:135], v[134:135], v[218:219]
    v_pk_add_f32 v[128:129], v[128:129], v[136:137]
    v_pk_add_f32 v[130:131], v[130:131], v[138:139]
    v_pk_add_f32 v[132:133], v[132:133], v[140:141]
    v_pk_add_f32 v[134:135], v[134:135], v[142:143]
    s_waitcnt lgkmcnt(0)
    v_pk_add_f32 v[144:145], v[144:145], v[152:153]
    v_pk_add_f32 v[146:147], v[146:147], v[154:155]
    v_pk_add_f32 v[148:149], v[148:149], v[156:157]
    v_pk_add_f32 v[150:151], v[150:151], v[158:159]
    v_pk_add_f32 v[128:129], v[128:129], v[144:145]
    v_pk_add_f32 v[130:131], v[130:131], v[146:147]
    v_pk_add_f32 v[132:133], v[132:133], v[148:149]
    v_pk_add_f32 v[134:135], v[134:135], v[150:151]
    v_cvt_pk_bf16_f32 v244, v128, v129
    v_cvt_pk_bf16_f32 v245, v130, v131
    v_cvt_pk_bf16_f32 v246, v132, v133
    v_cvt_pk_bf16_f32 v247, v134, v135
    buffer_store_dwordx4 v[244:247], v14, s[40:43], s48 offen
    s_or_b32 s48, s2, s38
    s_cmp_lg_u32 s48, 0
    s_cbranch_scc1 L_noepoch_18
    s_mov_b32 s48, 14336
    v_mov_b32 v2, s48
    v_mov_b32 v3, s75
    s_mov_b64 exec, 1
    buffer_store_dword v3, v2, s[60:63], 0 offen sc1
    s_mov_b64 exec, -1
L_noepoch_18:
    s_branch L_end
L_slowP_1:
    v_min_u32 v2, 20, v1
    v_mul_u32_u24 v3, 11, v2
    v_lshrrev_b32 v3, 5, v3
    v_mul_u32_u24 v3, 72, v3
    v_lshl_add_u32 v2, v2, 3, v3
    s_mul_i32 s48, s38, 24
    s_lshr_b32 s49, s37, 1
    s_add_u32 s48, s48, s49
    v_add_u32 v2, s48, v2
    v_lshlrev_b32 v2, 2, v2
    v_add_u32 v2, 20480, v2
    s_mov_b32 s51, 0
L_spinP_19:
    buffer_load_dword v3, v2, s[60:63], 0 offen sc1
    s_add_u32 s51, s51, 1
    s_waitcnt vmcnt(0)
    v_cmp_ne_u32 vcc, s75, v3
    s_cbranch_vccz L_sdoneP_20
    s_cmp_lt_u32 s51, 200000
    s_cbranch_scc1 L_spinP_19
L_sdoneP_20:
    s_branch L_okP_2
L_slowS_3:
    s_mov_b32 s51, 0
L_spinS_21:
    v_and_b32 v2, 31, v1
    v_lshlrev_b32 v2, 4, v2
    s_lshl_b32 s48, s36, 2
    s_add_u32 s48, s48, s38
    s_lshl_b32 s48, s48, 9
    s_add_u32 s48, s48, 24576
    buffer_load_dwordx4 v[22:25], v2, s[60:63], s48 offen sc1
    s_add_u32 s51, s51, 1
    s_waitcnt vmcnt(0)
    v_cmp_ne_u32 vcc, s75, v24
    s_cbranch_vccz L_okS_4
    s_cmp_lt_u32 s51, 200000
    s_cbranch_scc1 L_spinS_21
    s_branch L_okS_4
L_slowB_5:
    s_and_b32 s48, s37, 3
    s_mul_i32 s48, s48, 9
    s_mov_b32 s50, 0x6370a440
    s_mov_b32 s51, 0xb
    s_lshr_b64 s[50:51], s[50:51], s48
    v_min_u32 v2, 20, v1
    v_mul_u32_u24 v3, 11, v2
    v_lshrrev_b32 v3, 5, v3
    v_mul_u32_u24 v2, 3, v2
    v_mad_i32_i24 v2, v3, -9, v2
    v_lshrrev_b32 v2, v2, s50
    v_and_b32 v2, 7, v2
    v_mul_u32_u24 v3, 96, v3
    v_add_u32 v2, v2, v3
    s_mul_i32 s48, s38, 24
    s_lshr_b32 s49, s37, 2
    s_mul_i32 s49, s49, 6
    s_add_u32 s48, s48, s49
    v_add_u32 v2, s48, v2
    v_lshlrev_b32 v2, 2, v2
    v_add_u32 v2, 61440, v2
    s_mov_b32 s51, 0
L_spinB_22:
    buffer_load_dword v3, v2, s[60:63], 0 offen sc1
    s_add_u32 s51, s51, 1
    s_waitcnt vmcnt(0)
    v_cmp_ne_u32 vcc, s75, v3
    s_cbranch_vccz L_sdoneB_23
    s_cmp_lt_u32 s51, 200000
    s_cbranch_scc1 L_spinB_22
L_sdoneB_23:
    s_branch L_okB_6
L_slowW_7:
    s_min_u32 s48, s15, 6
    s_mul_i32 s48, s48, 144
    s_mul_i32 s49, s38, 28
    s_add_u32 s49, s49, s48
    s_lshl_b32 s50, s38, 3
    s_add_u32 s50, s50, s48
    s_add_u32 s50, s50, 84
    v_mov_b32 v2, s49
    v_mov_b32 v3, s50
    v_cmp_gt_u32 vcc, 28, v1
    s_nop 1
    v_cndmask_b32 v2, v3, v2, vcc
    v_min_u32 v3, 35, v1
    v_add_u32 v2, v2, v3
    v_lshlrev_b32 v2, 2, v2
    v_add_u32 v2, 16384, v2
    s_mov_b32 s51, 0
L_spinW_24:
    buffer_load_dword v3, v2, s[60:63], 0 offen sc1
    s_add_u32 s51, s51, 1
    s_waitcnt vmcnt(0)
    v_cmp_ne_u32 vcc, s75, v3
    s_cbranch_vccz L_sdoneW_25
    s_cmp_lt_u32 s51, 200000
    s_cbranch_scc1 L_spinW_24
L_sdoneW_25:
    s_branch L_okW_8
L_slowA_9:
    v_and_b32 v2, 7, v1
    v_lshlrev_b32 v2, 2, v2
    s_lshl_b32 s48, s14, 7
    s_lshl_b32 s49, s38, 5
    s_add_u32 s48, s48, s49
    v_add_u32 v2, s48, v2
    s_mov_b32 s51, 0
L_spinA_26:
    buffer_load_dword v3, v2, s[60:63], 0 offen sc1
    s_add_u32 s51, s51, 1
    s_waitcnt vmcnt(0)
    v_cmp_ne_u32 vcc, s75, v3
    s_cbranch_vccz L_sdoneA_27
    s_cmp_lt_u32 s51, 200000
    s_cbranch_scc1 L_spinA_26
L_sdoneA_27:
    s_branch L_okA_10
L_noph2_11:
    s_waitcnt vmcnt(0) lgkmcnt(0)
    s_lshl_b32 s50, s36, 8
    s_lshr_b32 s51, s38, 1
    s_lshl_b32 s51, s51, 7
    s_add_u32 s50, s50, s51
    s_lshl_b32 s51, s37, 3
    s_add_u32 s50, s50, s51
    s_and_b32 s51, s38, 1
    s_lshl_b32 s51, s51, 2
    s_add_u32 s50, s50, s51
    s_add_u32 s50, s50, 57344
    v_mov_b32 v2, s50
    v_mov_b32 v3, s75
    s_mov_b64 exec, 1
    buffer_store_dword v3, v2, s[60:63], 0 offen sc1
    s_mov_b64 exec, -1
    s_lshl_b32 s48, s37, 8
    s_add_u32 s48, s48, 8192
    v_lshlrev_b32 v2, 2, v1
    v_add_u32 v2, s48, v2
    s_mov_b32 s51, 0
L_spinKI_28:
    buffer_load_dword v3, v2, s[60:63], 0 offen sc1
    s_add_u32 s51, s51, 1
    s_waitcnt vmcnt(0)
    v_cmp_ne_u32 vcc, s75, v3
    s_cbranch_vccz L_sdoneKI_29
    s_cmp_lt_u32 s51, 200000
    s_cbranch_scc1 L_spinKI_28
L_sdoneKI_29:
    s_lshl_b32 s48, s37, 15
    s_lshl_b32 s49, s38, 10
    s_add_u32 s64, s48, s49
    buffer_load_dwordx4 v[144:147], v15, s[32:35], s64 offen sc1
    s_add_u32 s64, s64, 4096
    buffer_load_dwordx4 v[148:151], v15, s[32:35], s64 offen sc1
    s_add_u32 s64, s64, 4096
    buffer_load_dwordx4 v[152:155], v15, s[32:35], s64 offen sc1
    s_add_u32 s64, s64, 4096
    buffer_load_dwordx4 v[156:159], v15, s[32:35], s64 offen sc1
    s_add_u32 s64, s64, 4096
    buffer_load_dwordx4 v[160:163], v15, s[32:35], s64 offen sc1
    s_add_u32 s64, s64, 4096
    buffer_load_dwordx4 v[164:167], v15, s[32:35], s64 offen sc1
    s_add_u32 s64, s64, 4096
    buffer_load_dwordx4 v[168:171], v15, s[32:35], s64 offen sc1
    s_add_u32 s64, s64, 4096
    buffer_load_dwordx4 v[172:175], v15, s[32:35], s64 offen sc1
    v_lshrrev_b32 v2, 4, v1
    v_bfe_u32 v3, v1, 2, 2
    v_cmp_eq_u32 vcc, v2, v3
    v_and_b32 v2, 1, v1
    v_lshlrev_b32 v2, 4, v2
    v_mov_b32 v3, 0x3f80
    v_lshlrev_b32 v3, v2, v3
    v_cndmask_b32 v3, 0, v3, vcc
    v_and_b32 v2, 2, v1
    v_cmp_eq_u32 vcc, 0, v2
    s_nop 1
    v_cndmask_b32 v200, 0, v3, vcc
    v_cndmask_b32 v201, v3, 0, vcc
    v_mov_b32 v202, v200
    v_mov_b32 v203, v201
    s_waitcnt vmcnt(7)
    s_nop 0
    v_mfma_f32_16x16x32_bf16 v[184:187], v[200:203], v[144:147], 0
    s_waitcnt vmcnt(6)
    v_mfma_f32_16x16x32_bf16 v[184:187], v[200:203], v[148:151], v[184:187]
    s_waitcnt vmcnt(5)
    v_mfma_f32_16x16x32_bf16 v[184:187], v[200:203], v[152:155], v[184:187]
    s_waitcnt vmcnt(4)
    v_mfma_f32_16x16x32_bf16 v[184:187], v[200:203], v[156:159], v[184:187]
    s_waitcnt vmcnt(3)
    v_mfma_f32_16x16x32_bf16 v[184:187], v[200:203], v[160:163], v[184:187]
    s_waitcnt vmcnt(2)
    v_mfma_f32_16x16x32_bf16 v[184:187], v[200:203], v[164:167], v[184:187]
    s_waitcnt vmcnt(1)
    v_mfma_f32_16x16x32_bf16 v[184:187], v[200:203], v[168:171], v[184:187]
    s_waitcnt vmcnt(0)
    v_mfma_f32_16x16x32_bf16 v[184:187], v[200:203], v[172:175], v[184:187]
    s_nop 7
    v_cvt_pk_bf16_f32 v188, v184, v185
    v_cvt_pk_bf16_f32 v189, v186, v187
    s_lshr_b32 s48, s38, 1
    s_lshl_b32 s48, s48, 10
    s_and_b32 s49, s38, 1
    s_lshl_b32 s49, s49, 3
    s_add_u32 s48, s48, s49
    s_add_u32 s48, s48, 137728
    v_add_u32 v2, s48, v15
    ds_write_b64 v2, v[188:189]
    s_waitcnt lgkmcnt(0)
    s_barrier
    v_add_u32 v2, 137728, v15
    ds_read_b128 v[248:251], v2 offset:0
    ds_read_b128 v[252:255], v2 offset:1024
    s_waitcnt lgkmcnt(1)
    v_mfma_f32_32x32x16_bf16 v[204:219], v[248:251], v[176:179], 0
    s_waitcnt lgkmcnt(0)
    v_mfma_f32_32x32x16_bf16 v[204:219], v[252:255], v[180:183], v[204:219]
    s_nop 11
    v_mov_b32 v184, v216
    v_mov_b32 v185, v216
    s_nop 1
    v_permlane32_swap_b32 v184, v185
    v_add_f32 v184, 0x358637bd, v185
    v_rcp_f32 v184, v184
    s_nop 0
    v_mul_f32 v204, v204, v184
    v_mul_f32 v205, v205, v184
    v_cvt_pk_bf16_f32 v204, v204, v205
    v_mul_f32 v206, v206, v184
    v_mul_f32 v207, v207, v184
    v_cvt_pk_bf16_f32 v205, v206, v207
    v_mul_f32 v208, v208, v184
    v_mul_f32 v209, v209, v184
    v_cvt_pk_bf16_f32 v206, v208, v209
    v_mul_f32 v210, v210, v184
    v_mul_f32 v211, v211, v184
    v_cvt_pk_bf16_f32 v207, v210, v211
    v_mul_f32 v212, v212, v184
    v_mul_f32 v213, v213, v184
    v_cvt_pk_bf16_f32 v208, v212, v213
    v_mul_f32 v214, v214, v184
    v_mul_f32 v215, v215, v184
    v_cvt_pk_bf16_f32 v209, v214, v215
    v_mul_f32 v216, v216, v184
    v_mul_f32 v217, v217, v184
    v_cvt_pk_bf16_f32 v210, v216, v217
    v_mul_f32 v218, v218, v184
    v_mul_f32 v219, v219, v184
    v_cvt_pk_bf16_f32 v211, v218, v219
    v_cndmask_b32 v210, 0, v210, s[54:55]
    v_cndmask_b32 v211, 0, v211, s[54:55]
    s_lshl_b32 s50, s36, 2
    s_add_u32 s50, s50, s38
    s_mul_i32 s50, s50, 144
    s_lshl_b32 s51, s37, 1
    s_add_u32 s50, s50, s51
    s_add_u32 s50, s50, 112
    s_lshl_b32 s50, s50, 10
    buffer_store_dwordx4 v[204:207], v15, s[28:31], s50 offen offset:0 sc1
    buffer_store_dwordx4 v[208:211], v15, s[28:31], s50 offen offset:1024 sc1
    s_waitcnt vmcnt(0)
    s_lshl_b32 s50, s36, 8
    s_lshr_b32 s51, s38, 1
    s_lshl_b32 s51, s51, 7
    s_add_u32 s50, s50, s51
    s_lshl_b32 s51, s37, 3
    s_add_u32 s50, s50, s51
    s_and_b32 s51, s38, 1
    s_lshl_b32 s51, s51, 2
    s_add_u32 s50, s50, s51
    s_add_u32 s50, s50, 4096
    v_mov_b32 v2, s50
    v_mov_b32 v3, s75
    s_mov_b64 exec, 1
    buffer_store_dword v3, v2, s[60:63], 0 offen sc1
    s_mov_b64 exec, -1
    s_branch L_end
L_slowK_12:
    s_lshl_b32 s48, s37, 8
    s_add_u32 s48, s48, 8192
    v_lshlrev_b32 v2, 2, v1
    v_add_u32 v2, s48, v2
    s_mov_b32 s51, 0
L_spinK_30:
    buffer_load_dword v3, v2, s[60:63], 0 offen sc1
    s_add_u32 s51, s51, 1
    s_waitcnt vmcnt(0)
    v_cmp_ne_u32 vcc, s75, v3
    s_cbranch_vccz L_sdoneK_31
    s_cmp_lt_u32 s51, 200000
    s_cbranch_scc1 L_spinK_30
L_sdoneK_31:
    s_branch L_okK_13
L_slowA2_14:
    v_and_b32 v2, 7, v1
    v_lshlrev_b32 v2, 2, v2
    s_lshl_b32 s48, s14, 7
    s_lshl_b32 s49, s38, 5
    s_add_u32 s48, s48, s49
    s_add_u32 s48, s48, 57344
    v_add_u32 v2, s48, v2
    s_mov_b32 s51, 0
L_spinA2_32:
    buffer_load_dword v3, v2, s[60:63], 0 offen sc1
    s_add_u32 s51, s51, 1
    s_waitcnt vmcnt(0)
    v_cmp_ne_u32 vcc, s75, v3
    s_cbranch_vccz L_sdoneA2_33
    s_cmp_lt_u32 s51, 200000
    s_cbranch_scc1 L_spinA2_32
L_sdoneA2_33:
    s_branch L_okA2_15
L_slowO_16:
    v_and_b32 v2, 7, v1
    v_lshlrev_b32 v2, 2, v2
    s_lshl_b32 s48, s14, 7
    s_lshl_b32 s49, s38, 5
    s_add_u32 s48, s48, s49
    s_add_u32 s48, s48, 4096
    v_add_u32 v2, s48, v2
    s_mov_b32 s51, 0
L_spinO_34:
    buffer_load_dword v3, v2, s[60:63], 0 offen sc1
    s_add_u32 s51, s51, 1
    s_waitcnt vmcnt(0)
    v_cmp_ne_u32 vcc, s75, v3
    s_cbranch_vccz L_sdoneO_35
    s_cmp_lt_u32 s51, 200000
    s_cbranch_scc1 L_spinO_34
L_sdoneO_35:
    s_branch L_okO_17
L_end:
L_exit:
    s_endpgm
.section .rodata,"a"
.p2align 6
.amdhsa_kernel parallel_sum__linear_attn_block__glu_gated_reglu__prompt_kernel
  .amdhsa_next_free_vgpr 512
  .amdhsa_next_free_sgpr 102
  .amdhsa_accum_offset 256
  .amdhsa_group_segment_fixed_size 0
  .amdhsa_kernarg_size 80
  .amdhsa_user_sgpr_count 2
  .amdhsa_user_sgpr_kernarg_segment_ptr 1
  .amdhsa_system_sgpr_workgroup_id_x 1
.end_amdhsa_kernel
```
